```python
import torch

def _softmax(x, axis=-1):
    return torch.softmax(x, dim=axis)
def _gelu(x):
    return torch.nn.functional.gelu(x, approximate="tanh")
def _silu(x):
    return torch.nn.functional.silu(x)
def _sigmoid(x):
    return torch.sigmoid(x)
def _layernorm(x, axis=-1, eps=1e-5):
    m = x.mean(dim=axis, keepdim=True)
    v = x.var(dim=axis, keepdim=True, unbiased=False)
    return (x - m) / torch.sqrt(v + eps)
def _scatter_add(tgt, idx, src, axis=0):
    return tgt.clone().index_add_(axis, idx, src)
def _segment_sum(src, seg, n):
    out = torch.zeros((n,) + src.shape[1:], dtype=src.dtype)
    return out.index_add_(0, seg, src)
def _pad(x, pw):
    flat = tuple(v for pair in reversed(pw) for v in pair)
    return torch.nn.functional.pad(x, flat)

kernel_name = 'gated_mix__linear_attn_block__glu_gated_swiglu__prompt'

def setup_inputs():

    _w = (lambda a: (lambda t: t.to(torch.bfloat16) if t.is_floating_point() else t)(torch.as_tensor(a)))
    def _A_setup():
        B, S, D = 1, 2048, 512
        return {
            "x": _w((lambda *s: torch.randn(*s, dtype=torch.bfloat16) * 0.05)(B, S, D)),
            "wqkv": _w((lambda *s: torch.randn(*s, dtype=torch.bfloat16) * 0.8)(D, 3 * D)),
            "wo": _w((lambda *s: torch.randn(*s, dtype=torch.bfloat16) * 0.05)(D, D)),
        }
    _A_in = _A_setup()

    def _B_setup():
        B, S, D, F = 1, 2048, 512, 1792
        return {
            "x": _w((lambda *s: torch.randn(*s, dtype=torch.bfloat16) * 0.05)(B, S, D)),
            "w1": _w((lambda *s: torch.randn(*s, dtype=torch.bfloat16) * 1.6)(D, F) * (2.0 / D) ** 0.5),
            "w3": _w((lambda *s: torch.randn(*s, dtype=torch.bfloat16) * 1.6)(D, F) * (2.0 / D) ** 0.5),
            "w2": _w((lambda *s: torch.randn(*s, dtype=torch.bfloat16) * 1.6)(F, D) * (2.0 / F) ** 0.5),
        }
    _B_in = _B_setup()

    return {
        "A_x": _A_in["x"],
        "A_wqkv": _A_in["wqkv"],
        "A_wo": _A_in["wo"],
        "B_x": _B_in["x"],
        "B_w1": _B_in["w1"],
        "B_w3": _B_in["w3"],
        "B_w2": _B_in["w2"],
        "gate_w": _w((lambda *s: torch.randn(*s, dtype=torch.bfloat16) * 0.05)(512) * 16.0),
    }

def reference(A_x, A_wqkv, A_wo, B_x, B_w1, B_w3, B_w2, gate_w):
    def _A_ref(x, wqkv, wo):
        B, S, D = x.shape
        H = 32; Dh = D // H
        qkv = (lambda x, *d: x.permute(*d))((x @ wqkv).reshape(B, S, 3, H, Dh), 2, 0, 3, 1, 4)
        q, k, v = qkv[0], qkv[1], qkv[2]
        phi = lambda t: torch.where(t > 0, t + 1, torch.exp(t)) + 1e-6
        pq, pk = phi(q), phi(k)
        kv = torch.einsum("bhsd,bhse->bhde", pk, v)
        z = torch.einsum("bhsd->bhd", pk)
        num = torch.einsum("bhqd,bhde->bhqe", pq, kv)
        den = torch.einsum("bhqd,bhd->bhq", pq, z)[..., None] + 1e-6
        o = num / den
        return (lambda x, *d: x.permute(*d))(o, 0, 2, 1, 3).reshape(B, S, D) @ wo

    def _B_ref(x, w1, w3, w2):
        gate = torch.einsum("bsd,df->bsf", x, w1)
        up = torch.einsum("bsd,df->bsf", x, w3)
        h = _silu(gate) * up
        out = torch.einsum("bsf,fd->bsd", h, w2)
        return out

    x = A_x
    g = _sigmoid((x * gate_w).sum(-1, keepdims=True))
    a = _A_ref(x, A_wqkv, A_wo)
    b = _B_ref(x, B_w1, B_w3, B_w2)
    return g * a + (1 - g) * b
```

```asm
; @launch grid=(256,1,1) block=(512,1,1) lds=163840
.amdgcn_target "amdgcn-amd-amdhsa--gfx950"
.text
.globl gated_mix__linear_attn_block__glu_gated_swiglu__prompt_kernel
.p2align 8
.type gated_mix__linear_attn_block__glu_gated_swiglu__prompt_kernel,@function
gated_mix__linear_attn_block__glu_gated_swiglu__prompt_kernel:
  s_cmp_ge_u32 s2, 256
  s_cbranch_scc1 L_end
  s_load_dwordx16 s[48:63], s[0:1], 0
  s_load_dwordx4 s[64:67], s[0:1], 64
  s_load_dwordx2 s[68:69], s[0:1], 80
  s_getpc_b64 s[4:5]
L_pc:
  s_mov_b32 s7, L_pathD-L_pc
  s_bitcmp1_b32 s2, 7
  s_cselect_b32 s6, L_pathD-L_pc, 0
  s_cselect_b32 s7, L_end-L_pathD-128, s7
  s_add_u32 s4, s4, s6
  s_addc_u32 s5, s5, 0
  v_lshlrev_b32 v2, 7, v0
  v_cmp_gt_u32 vcc, s7, v2
  s_nop 0
  s_and_saveexec_b64 s[6:7], vcc
  s_cbranch_execz L_ct_skip
  global_load_dword v125, v2, s[4:5]
L_ct_skip:
  s_mov_b64 exec, -1
  v_and_b32 v1, 63, v0
  v_lshrrev_b32 v24, 6, v0
  s_nop 0
  v_readfirstlane_b32 s3, v24
  v_lshlrev_b32 v2, 4, v1
  s_and_b32 s8, s2, 7
  s_lshr_b32 s9, s2, 3
  s_and_b32 s4, s8, 1
  s_lshl_b32 s4, s4, 3
  s_and_b32 s10, s9, 7
  s_add_u32 s4, s4, s10
  s_lshr_b32 s95, s8, 1
  s_lshr_b32 s96, s9, 3
  s_lshl_b32 s5, s95, 2
  s_add_u32 s5, s5, s96
  s_lshl_b32 s6, s8, 2
  s_and_b32 s10, s9, 3
  s_add_u32 s6, s6, s10
  s_lshr_b32 s7, s9, 2
  s_and_b32 s72, s3, 3
  s_lshr_b32 s73, s3, 2
  s_lshl_b32 s90, s96, 1
  s_add_u32 s90, s90, s4
  s_and_b32 s90, s90, 7
  s_lshl_b32 s77, s4, 2
  s_add_u32 s77, s77, s72
  s_lshl_b32 s78, s77, 15
  s_lshl_b32 s79, s73, 14
  s_add_u32 s78, s78, s79
  v_lshrrev_b32 v24, 3, v1
  v_and_b32 v25, 7, v1
  v_lshrrev_b32 v26, 4, v1
  v_xor_b32 v27, v25, v26
  v_lshlrev_b32 v24, 10, v24
  v_add_u32 v24, s78, v24
  v_lshl_add_u32 v3, v27, 4, v24
  v_xor_b32 v27, 4, v27
  v_lshl_add_u32 v4, v27, 4, v24
  v_add_u32 v4, 7168, v4
  s_lshl_b32 s77, s77, 2
  s_add_u32 s77, s77, s95
  s_mul_i32 s84, s77, 36864
  s_lshl_b32 s88, s72, 12
  s_lshl_b32 s79, s73, 11
  s_add_u32 s88, s88, s79
  s_lshl_b32 s89, s72, 14
  s_add_u32 s89, s89, s79
  s_add_u32 s89, s89, 65536
  s_waitcnt lgkmcnt(0)
  s_mov_b64 s[8:9], s[48:49]
  s_mov_b32 s10, 2097152
  s_mov_b32 s11, 131072
  s_mov_b64 s[12:13], s[50:51]
  s_mov_b32 s14, 1572864
  s_mov_b32 s15, 131072
  s_mov_b64 s[16:17], s[56:57]
  s_mov_b32 s18, 1835008
  s_mov_b32 s19, 131072
  s_mov_b64 s[20:21], s[58:59]
  s_mov_b32 s22, 1835008
  s_mov_b32 s23, 131072
  s_mov_b64 s[28:29], s[52:53]
  s_mov_b32 s30, 524288
  s_mov_b32 s31, 131072
  s_mov_b64 s[24:25], s[60:61]
  s_mov_b32 s26, 1835008
  s_mov_b32 s27, 131072
  s_mov_b64 s[36:37], s[64:65]
  s_mov_b32 s38, 2097152
  s_mov_b32 s39, 131072
  s_mov_b64 s[40:41], s[66:67]
  s_mov_b32 s42, 256
  s_mov_b32 s43, 131072
  s_mov_b64 s[32:33], s[68:69]
  s_mov_b32 s34, 16777216
  s_mov_b32 s35, 131072
  s_mov_b64 s[0:1], s[62:63]
  s_xor_b32 s48, s90, 0
  s_lshl_b32 s48, s48, 7
  s_xor_b32 s49, s90, 1
  s_lshl_b32 s49, s49, 7
  s_xor_b32 s50, s90, 2
  s_lshl_b32 s50, s50, 7
  s_xor_b32 s51, s90, 3
  s_lshl_b32 s51, s51, 7
  s_xor_b32 s52, s90, 4
  s_lshl_b32 s52, s52, 7
  s_xor_b32 s53, s90, 5
  s_lshl_b32 s53, s53, 7
  s_xor_b32 s54, s90, 6
  s_lshl_b32 s54, s54, 7
  s_xor_b32 s55, s90, 7
  s_lshl_b32 s55, s55, 7
  s_cmp_ge_u32 s96, 2
  s_cbranch_scc1 L_pathD
  s_add_u32 m0, s89, 0
  s_nop 0
  buffer_load_dwordx4 v3, s[8:11], s48 offen lds
  buffer_load_dwordx4 v4, s[8:11], s48 offen offset:1024 lds
  s_mov_b32 s44, s12
  s_mov_b32 s45, s13
  s_mov_b32 s46, s14
  s_mov_b32 s47, 131072
  s_mul_i32 s56, s48, 1536
  s_mul_i32 s77, s72, 49152
  s_lshl_b32 s78, s95, 1
  s_add_u32 s78, s78, s96
  s_lshl_b32 s78, s78, 7
  s_add_u32 s77, s77, s78
  s_lshl_b32 s78, s73, 10
  s_add_u32 s77, s77, s78
  s_add_u32 s77, s77, 1024
  v_lshrrev_b32 v24, 3, v1
  v_mul_u32_u24 v24, 3072, v24
  v_and_b32 v25, 1, v1
  v_lshl_add_u32 v24, v25, 4, v24
  v_add_u32 v24, s77, v24
  v_bfe_u32 v25, v1, 1, 2
  v_bfe_u32 v26, v1, 4, 1
  v_lshlrev_b32 v26, 1, v26
  v_xor_b32 v25, v25, v26
  v_xor_b32 v25, s73, v25
  v_lshl_add_u32 v9, v25, 5, v24
  v_add_u32 v10, 23552, v9
  s_add_u32 m0, s88, 0
  s_nop 0
  buffer_load_dwordx4 v9, s[44:47], s56 offen lds
  buffer_load_dwordx4 v10, s[44:47], s56 offen offset:1024 lds
  s_add_u32 m0, s89, 4096
  s_nop 0
  buffer_load_dwordx4 v3, s[8:11], s49 offen lds
  buffer_load_dwordx4 v4, s[8:11], s49 offen offset:1024 lds
  s_mul_i32 s56, s48, 1536
  s_mul_i32 s57, s49, 1536
  s_mul_i32 s58, s50, 1536
  s_mul_i32 s59, s51, 1536
  s_mul_i32 s60, s52, 1536
  s_mul_i32 s61, s53, 1536
  s_mul_i32 s62, s54, 1536
  s_mul_i32 s63, s55, 1536
  s_add_u32 m0, s88, 16384
  s_nop 0
  buffer_load_dwordx4 v9, s[44:47], s57 offen lds
  buffer_load_dwordx4 v10, s[44:47], s57 offen offset:1024 lds
  s_add_u32 m0, s89, 8192
  s_nop 0
  buffer_load_dwordx4 v3, s[8:11], s50 offen lds
  buffer_load_dwordx4 v4, s[8:11], s50 offen offset:1024 lds
  s_lshr_b32 s90, s2, 3
  s_lshl_b32 s90, s90, 3
  s_add_u32 s90, s90, s3
  s_mov_b32 s74, 1069066811
  s_mov_b32 s75, 3216550459
  s_mov_b32 s76, 897988541
  s_mov_b32 s80, 4294901760
  s_mov_b32 s81, 4294901760
  v_mov_b32 v23, 0
  s_or_b32 s77, s2, s3
  s_cmp_lg_u32 s77, 0
  s_cbranch_scc1 LC_nonce_pub
  s_memrealtime s[82:83]
  s_waitcnt lgkmcnt(0)
  s_or_b32 s82, s82, 1
  v_mov_b32 v126, s82
  v_mov_b32 v127, s83
  s_mov_b64 exec, 1
  buffer_store_dwordx2 v[126:127], v23, s[40:43], 0 offen sc1
  buffer_store_dwordx2 v[126:127], v23, s[40:43], 0 offen offset:128 sc1
  s_mov_b64 exec, -1
  s_nop 1
LC_nonce_pub:
  s_and_b32 s99, s2, 1
  s_lshl_b32 s99, s99, 7
  s_lshl_b32 s77, s4, 4
  s_add_u32 s77, s77, s5
  s_lshl_b32 s77, s77, 7
  s_add_u32 s2, s77, 11599872
  v_and_b32 v24, 31, v1
  v_bfe_u32 v25, v1, 1, 3
  v_lshrrev_b32 v26, 5, v1
  v_xor_b32 v25, v25, v26
  v_lshlrev_b32 v24, 7, v24
  s_lshl_b32 s77, s72, 14
  s_add_u32 s77, s77, 65536
  v_add_u32 v24, s77, v24
  v_xor_b32 v27, 0, v25
  v_lshl_add_u32 v5, v27, 4, v24
  v_xor_b32 v27, 2, v25
  v_lshl_add_u32 v6, v27, 4, v24
  v_xor_b32 v27, 4, v25
  v_lshl_add_u32 v7, v27, 4, v24
  v_xor_b32 v27, 6, v25
  v_lshl_add_u32 v8, v27, 4, v24
  v_lshrrev_b32 v24, 5, v1
  v_bfe_u32 v25, v1, 2, 2
  v_lshl_add_u32 v21, v24, 3, v25
  v_and_b32 v26, 3, v1
  v_and_b32 v27, 1, v26
  v_lshrrev_b32 v25, 1, v26
  v_lshl_or_b32 v27, v27, 1, v25
  v_lshlrev_b32 v24, 7, v21
  v_bfe_u32 v25, v1, 4, 1
  s_lshl_b32 s77, s73, 1
  v_lshl_add_u32 v27, v27, 3, v24
  v_lshl_add_u32 v24, v26, 3, v24
  v_bfe_u32 v26, v1, 3, 1
  v_lshl_or_b32 v26, v26, 1, v25
  v_xor_b32 v26, s77, v26
  v_lshl_add_u32 v13, v26, 5, v24
  v_xor_b32 v26, 1, v26
  v_add_u32 v27, 2048, v27
  v_lshl_add_u32 v14, v26, 5, v27
  v_add_u32 v15, 65536, v13
  v_add_u32 v16, 65536, v14
  v_mov_b32 v80, s76
  v_mov_b32 v81, s76
  v_mov_b32 v82, s76
  v_mov_b32 v83, s76
  v_mov_b32 v84, s76
  v_mov_b32 v85, s76
  v_mov_b32 v86, s76
  v_mov_b32 v87, s76
  v_mov_b32 v88, s76
  v_mov_b32 v89, s76
  v_mov_b32 v90, s76
  v_mov_b32 v91, s76
  v_mov_b32 v92, s76
  v_mov_b32 v93, s76
  v_mov_b32 v94, s76
  v_mov_b32 v95, s76
  s_lshl_b32 s77, s4, 7
  s_lshl_b32 s78, s5, 3
  s_add_u32 s77, s77, s78
  s_add_u32 s94, s77, s3
  s_lshl_b32 s77, s94, 10
  buffer_load_dwordx4 v[112:115], v2, s[8:11], s77 offen
  global_load_dwordx4 v[116:119], v2, s[0:1]
  s_waitcnt vmcnt(10)
  s_barrier
  ds_read_b128 a[0:3], v5
  ds_read_b128 a[4:7], v6
  ds_read_b128 a[8:11], v7
  ds_read_b128 a[12:15], v8
  s_waitcnt vmcnt(6)
  s_barrier
  ds_read_b64_tr_b16 v[28:29], v13
  ds_read_b64_tr_b16 v[30:31], v13 offset:512
  ds_read_b64_tr_b16 v[32:33], v14
  ds_read_b64_tr_b16 v[34:35], v14 offset:512
  ds_read_b64_tr_b16 v[36:37], v13 offset:4096
  ds_read_b64_tr_b16 v[38:39], v13 offset:4608
  s_waitcnt lgkmcnt(2)
  v_mfma_f32_32x32x16_bf16 v[48:63], a[0:3], v[28:31], v[80:95]
  ds_read_b64_tr_b16 v[40:41], v14 offset:4096
  ds_read_b64_tr_b16 v[42:43], v14 offset:4608
  s_add_u32 m0, s89, 12288
  s_nop 0
  buffer_load_dwordx4 v3, s[8:11], s51 offen lds
  ds_read_b128 a[16:19], v5 offset:4096
  v_mfma_f32_32x32x16_bf16 v[64:79], a[0:3], v[32:35], 0
  ds_read_b64_tr_b16 v[44:45], v13 offset:8192
  ds_read_b64_tr_b16 v[46:47], v13 offset:8704
  ds_read_b128 a[20:23], v6 offset:4096
  s_waitcnt lgkmcnt(4)
  v_mfma_f32_32x32x16_bf16 v[48:63], a[4:7], v[36:39], v[48:63]
  ds_read_b64_tr_b16 v[28:29], v14 offset:8192
  ds_read_b64_tr_b16 v[30:31], v14 offset:8704
  buffer_load_dwordx4 v4, s[8:11], s51 offen offset:1024 lds
  ds_read_b128 a[24:27], v7 offset:4096
  v_mfma_f32_32x32x16_bf16 v[64:79], a[4:7], v[40:43], v[64:79]
  ds_read_b64_tr_b16 v[32:33], v13 offset:12288
  ds_read_b64_tr_b16 v[34:35], v13 offset:12800
  ds_read_b128 a[28:31], v8 offset:4096
  s_waitcnt lgkmcnt(4)
  v_mfma_f32_32x32x16_bf16 v[48:63], a[8:11], v[44:47], v[48:63]
  ds_read_b64_tr_b16 v[36:37], v14 offset:12288
  ds_read_b64_tr_b16 v[38:39], v14 offset:12800
  s_add_u32 m0, s88, 32768
  s_nop 0
  buffer_load_dwordx4 v9, s[44:47], s58 offen lds
  v_mfma_f32_32x32x16_bf16 v[64:79], a[8:11], v[28:31], v[64:79]
  s_waitcnt vmcnt(5)
  s_barrier
  ds_read_b64_tr_b16 v[40:41], v13 offset:16384
  ds_read_b64_tr_b16 v[42:43], v13 offset:16896
  s_waitcnt lgkmcnt(2)
  v_mfma_f32_32x32x16_bf16 v[48:63], a[12:15], v[32:35], v[48:63]
  ds_read_b64_tr_b16 v[44:45], v14 offset:16384
  ds_read_b64_tr_b16 v[46:47], v14 offset:16896
  buffer_load_dwordx4 v10, s[44:47], s58 offen offset:1024 lds
  v_mfma_f32_32x32x16_bf16 v[64:79], a[12:15], v[36:39], v[64:79]
  ds_read_b64_tr_b16 v[28:29], v13 offset:20480
  ds_read_b64_tr_b16 v[30:31], v13 offset:20992
  s_waitcnt lgkmcnt(2)
  v_mfma_f32_32x32x16_bf16 v[48:63], a[16:19], v[40:43], v[48:63]
  ds_read_b64_tr_b16 v[32:33], v14 offset:20480
  ds_read_b64_tr_b16 v[34:35], v14 offset:20992
  s_add_u32 m0, s88, 49152
  s_nop 0
  buffer_load_dwordx4 v9, s[44:47], s59 offen lds
  ds_read_b128 a[32:35], v5 offset:8192
  s_mul_i32 s77, s72, 57344
  s_mul_i32 s78, s95, 896
  s_add_u32 s77, s77, s78
  s_lshl_b32 s78, s96, 7
  s_add_u32 s77, s77, s78
  v_lshrrev_b32 v24, 3, v1
  v_mul_u32_u24 v24, 3584, v24
  v_and_b32 v25, 1, v1
  v_lshl_add_u32 v24, v25, 4, v24
  v_add_u32 v24, s77, v24
  v_bfe_u32 v25, v1, 1, 2
  v_bfe_u32 v26, v1, 4, 1
  v_lshlrev_b32 v26, 1, v26
  v_xor_b32 v25, v25, v26
  v_xor_b32 v25, s73, v25
  v_lshl_add_u32 v11, v25, 5, v24
  v_add_u32 v12, 27648, v11
  s_lshl_b32 s77, s95, 1
  s_add_u32 s77, s77, s96
  s_lshl_b32 s77, s77, 3
  s_add_u32 s77, s77, s3
  s_lshl_b32 s77, s77, 10
  s_add_u32 s77, s77, 10485760
  v_mov_b32 v122, 0
  v_mov_b32 v123, 0
  v_mov_b32 v124, 0
  v_mov_b32 v125, 0
  s_cmp_eq_u32 s4, 0
  s_cselect_b64 exec, -1, 0
  buffer_store_dwordx4 v[122:125], v2, s[32:35], s77 offen sc1
  s_mov_b64 exec, -1
  v_mfma_f32_32x32x16_bf16 v[64:79], a[16:19], v[44:47], v[64:79]
  ds_read_b64_tr_b16 v[36:37], v13 offset:24576
  ds_read_b64_tr_b16 v[38:39], v13 offset:25088
  ds_read_b128 a[36:39], v6 offset:8192
  s_waitcnt lgkmcnt(4)
  v_mfma_f32_32x32x16_bf16 v[48:63], a[20:23], v[28:31], v[48:63]
  ds_read_b64_tr_b16 v[40:41], v14 offset:24576
  ds_read_b64_tr_b16 v[42:43], v14 offset:25088
  buffer_load_dwordx4 v10, s[44:47], s59 offen offset:1024 lds
  ds_read_b128 a[40:43], v7 offset:8192
  v_mfma_f32_32x32x16_bf16 v[64:79], a[20:23], v[32:35], v[64:79]
  ds_read_b64_tr_b16 v[44:45], v13 offset:28672
  ds_read_b64_tr_b16 v[46:47], v13 offset:29184
  ds_read_b128 a[44:47], v8 offset:8192
  s_waitcnt lgkmcnt(4)
  v_mfma_f32_32x32x16_bf16 v[48:63], a[24:27], v[36:39], v[48:63]
  ds_read_b64_tr_b16 v[28:29], v14 offset:28672
  ds_read_b64_tr_b16 v[30:31], v14 offset:29184
  s_add_u32 m0, s89, 0
  s_nop 0
  buffer_load_dwordx4 v3, s[8:11], s52 offen lds
  v_mfma_f32_32x32x16_bf16 v[64:79], a[24:27], v[40:43], v[64:79]
  s_waitcnt vmcnt(3)
  s_barrier
  ds_read_b64_tr_b16 v[32:33], v13 offset:32768
  ds_read_b64_tr_b16 v[34:35], v13 offset:33280
  s_waitcnt lgkmcnt(2)
  v_mfma_f32_32x32x16_bf16 v[48:63], a[28:31], v[44:47], v[48:63]
  ds_read_b64_tr_b16 v[36:37], v14 offset:32768
  ds_read_b64_tr_b16 v[38:39], v14 offset:33280
  buffer_load_dwordx4 v4, s[8:11], s52 offen offset:1024 lds
  v_mfma_f32_32x32x16_bf16 v[64:79], a[28:31], v[28:31], v[64:79]
  ds_read_b64_tr_b16 v[40:41], v13 offset:36864
  ds_read_b64_tr_b16 v[42:43], v13 offset:37376
  s_waitcnt lgkmcnt(2)
  v_mfma_f32_32x32x16_bf16 v[48:63], a[32:35], v[32:35], v[48:63]
  ds_read_b64_tr_b16 v[44:45], v14 offset:36864
  ds_read_b64_tr_b16 v[46:47], v14 offset:37376
  s_add_u32 m0, s89, 4096
  s_nop 0
  buffer_load_dwordx4 v3, s[8:11], s53 offen lds
  ds_read_b128 a[48:51], v5 offset:12288
  v_mov_b32 v120, 0
  v_dot2c_f32_bf16 v120, v112, v116
  v_mfma_f32_32x32x16_bf16 v[64:79], a[32:35], v[36:39], v[64:79]
  ds_read_b64_tr_b16 v[28:29], v13 offset:40960
  ds_read_b64_tr_b16 v[30:31], v13 offset:41472
  ds_read_b128 a[52:55], v6 offset:12288
  v_dot2c_f32_bf16 v120, v113, v117
  s_waitcnt lgkmcnt(4)
  v_mfma_f32_32x32x16_bf16 v[48:63], a[36:39], v[40:43], v[48:63]
  ds_read_b64_tr_b16 v[32:33], v14 offset:40960
  ds_read_b64_tr_b16 v[34:35], v14 offset:41472
  buffer_load_dwordx4 v4, s[8:11], s53 offen offset:1024 lds
  ds_read_b128 a[56:59], v7 offset:12288
  v_dot2c_f32_bf16 v120, v114, v118
  v_mfma_f32_32x32x16_bf16 v[64:79], a[36:39], v[44:47], v[64:79]
  ds_read_b64_tr_b16 v[36:37], v13 offset:45056
  ds_read_b64_tr_b16 v[38:39], v13 offset:45568
  ds_read_b128 a[60:63], v8 offset:12288
  v_dot2c_f32_bf16 v120, v115, v119
  s_nop 2
  v_add_f32 v120, v120, v120 quad_perm:[1,0,3,2] row_mask:0xf bank_mask:0xf
  s_waitcnt lgkmcnt(4)
  v_mfma_f32_32x32x16_bf16 v[48:63], a[40:43], v[28:31], v[48:63]
  ds_read_b64_tr_b16 v[40:41], v14 offset:45056
  ds_read_b64_tr_b16 v[42:43], v14 offset:45568
  s_add_u32 m0, s88, 0
  s_nop 0
  buffer_load_dwordx4 v9, s[44:47], s60 offen lds
  v_add_f32 v120, v120, v120 quad_perm:[2,3,0,1] row_mask:0xf bank_mask:0xf
  v_mfma_f32_32x32x16_bf16 v[64:79], a[40:43], v[32:35], v[64:79]
  s_waitcnt vmcnt(3)
  s_barrier
  ds_read_b64_tr_b16 v[44:45], v13 offset:49152
  ds_read_b64_tr_b16 v[46:47], v13 offset:49664
  v_add_f32 v120, v120, v120 row_half_mirror row_mask:0xf bank_mask:0xf
  s_waitcnt lgkmcnt(2)
  v_mfma_f32_32x32x16_bf16 v[48:63], a[44:47], v[36:39], v[48:63]
  ds_read_b64_tr_b16 v[28:29], v14 offset:49152
  ds_read_b64_tr_b16 v[30:31], v14 offset:49664
  buffer_load_dwordx4 v10, s[44:47], s60 offen offset:1024 lds
  v_add_f32 v120, v120, v120 row_mirror row_mask:0xf bank_mask:0xf
  s_nop 1
  v_add_f32 v120, v120, v120 row_bcast:15 row_mask:0xa bank_mask:0xf
  v_mfma_f32_32x32x16_bf16 v[64:79], a[44:47], v[40:43], v[64:79]
  ds_read_b64_tr_b16 v[32:33], v13 offset:53248
  ds_read_b64_tr_b16 v[34:35], v13 offset:53760
  v_add_f32 v120, v120, v120 row_bcast:31 row_mask:0xc bank_mask:0xf
  s_waitcnt lgkmcnt(2)
  v_mfma_f32_32x32x16_bf16 v[48:63], a[48:51], v[44:47], v[48:63]
  ds_read_b64_tr_b16 v[36:37], v14 offset:53248
  ds_read_b64_tr_b16 v[38:39], v14 offset:53760
  s_add_u32 m0, s89, 8192
  s_nop 0
  buffer_load_dwordx4 v3, s[8:11], s54 offen lds
  ds_read_b128 a[64:67], v5
  v_and_b32 v26, 3, v1
  v_and_b32 v27, 1, v26
  v_lshrrev_b32 v25, 1, v26
  v_lshl_or_b32 v27, v27, 1, v25
  v_lshlrev_b32 v24, 7, v21
  v_bfe_u32 v25, v1, 4, 1
  s_lshl_b32 s77, s73, 1
  v_lshl_add_u32 v24, v27, 3, v24
  v_lshl_add_u32 v24, v25, 11, v24
  v_bfe_u32 v26, v1, 3, 1
  v_lshl_or_b32 v26, v26, 1, v25
  v_xor_b32 v26, s77, v26
  v_lshl_add_u32 v17, v26, 5, v24
  v_xor_b32 v26, 1, v26
  v_lshl_add_u32 v18, v26, 5, v24
  v_add_u32 v19, 65536, v17
  v_add_u32 v20, 65536, v18
  v_mul_f32 v120, s75, v120
  v_mfma_f32_32x32x16_bf16 v[64:79], a[48:51], v[28:31], v[64:79]
  ds_read_b64_tr_b16 v[40:41], v13 offset:57344
  ds_read_b64_tr_b16 v[42:43], v13 offset:57856
  ds_read_b128 a[68:71], v6
  v_exp_f32 v120, v120
  s_nop 0
  v_add_f32 v120, 1.0, v120
  s_waitcnt lgkmcnt(4)
  v_mfma_f32_32x32x16_bf16 v[48:63], a[52:55], v[32:35], v[48:63]
  ds_read_b64_tr_b16 v[44:45], v14 offset:57344
  ds_read_b64_tr_b16 v[46:47], v14 offset:57856
  buffer_load_dwordx4 v4, s[8:11], s54 offen offset:1024 lds
  ds_read_b128 a[72:75], v7
  v_rcp_f32 v120, v120
  v_mfma_f32_32x32x16_bf16 v[64:79], a[52:55], v[36:39], v[64:79]
  ds_read_b64_tr_b16 v[28:29], v13 offset:61440
  ds_read_b64_tr_b16 v[30:31], v13 offset:61952
  ds_read_b128 a[76:79], v8
  s_lshl_b32 s77, s94, 2
  s_add_u32 s77, s77, 11534336
  s_mov_b32 exec_lo, 0
  s_mov_b32 exec_hi, 0x80000000
  buffer_store_dword v120, v23, s[32:35], s77 offen sc1
  s_mov_b64 exec, -1
  s_waitcnt lgkmcnt(4)
  v_mfma_f32_32x32x16_bf16 v[48:63], a[56:59], v[40:43], v[48:63]
  ds_read_b64_tr_b16 v[32:33], v14 offset:61440
  ds_read_b64_tr_b16 v[34:35], v14 offset:61952
  s_add_u32 m0, s88, 16384
  s_nop 0
  buffer_load_dwordx4 v9, s[44:47], s61 offen lds
  v_mfma_f32_32x32x16_bf16 v[64:79], a[56:59], v[44:47], v[64:79]
  s_waitcnt vmcnt(4)
  s_barrier
  ds_read_b64_tr_b16 v[36:37], v13
  ds_read_b64_tr_b16 v[38:39], v13 offset:512
  s_waitcnt lgkmcnt(2)
  v_mfma_f32_32x32x16_bf16 v[48:63], a[60:63], v[28:31], v[48:63]
  ds_read_b64_tr_b16 v[40:41], v14
  ds_read_b64_tr_b16 v[42:43], v14 offset:512
  buffer_load_dwordx4 v10, s[44:47], s61 offen offset:1024 lds
  v_mfma_f32_32x32x16_bf16 v[64:79], a[60:63], v[32:35], v[64:79]
  ds_read_b64_tr_b16 v[44:45], v13 offset:4096
  ds_read_b64_tr_b16 v[46:47], v13 offset:4608
  s_waitcnt lgkmcnt(2)
  v_mfma_f32_32x32x16_bf16 v[48:63], a[64:67], v[36:39], v[48:63]
  ds_read_b64_tr_b16 v[28:29], v14 offset:4096
  ds_read_b64_tr_b16 v[30:31], v14 offset:4608
  s_add_u32 m0, s89, 12288
  s_nop 0
  buffer_load_dwordx4 v3, s[8:11], s55 offen lds
  ds_read_b128 a[80:83], v5 offset:4096
  v_mfma_f32_32x32x16_bf16 v[64:79], a[64:67], v[40:43], v[64:79]
  ds_read_b64_tr_b16 v[32:33], v13 offset:8192
  ds_read_b64_tr_b16 v[34:35], v13 offset:8704
  ds_read_b128 a[84:87], v6 offset:4096
  s_waitcnt lgkmcnt(4)
  v_mfma_f32_32x32x16_bf16 v[48:63], a[68:71], v[44:47], v[48:63]
  ds_read_b64_tr_b16 v[36:37], v14 offset:8192
  ds_read_b64_tr_b16 v[38:39], v14 offset:8704
  buffer_load_dwordx4 v4, s[8:11], s55 offen offset:1024 lds
  ds_read_b128 a[88:91], v7 offset:4096
  v_mfma_f32_32x32x16_bf16 v[64:79], a[68:71], v[28:31], v[64:79]
  ds_read_b64_tr_b16 v[40:41], v13 offset:12288
  ds_read_b64_tr_b16 v[42:43], v13 offset:12800
  ds_read_b128 a[92:95], v8 offset:4096
  s_waitcnt lgkmcnt(4)
  v_mfma_f32_32x32x16_bf16 v[48:63], a[72:75], v[32:35], v[48:63]
  ds_read_b64_tr_b16 v[44:45], v14 offset:12288
  ds_read_b64_tr_b16 v[46:47], v14 offset:12800
  s_add_u32 m0, s88, 32768
  s_nop 0
  buffer_load_dwordx4 v9, s[44:47], s62 offen lds
  v_mfma_f32_32x32x16_bf16 v[64:79], a[72:75], v[36:39], v[64:79]
  s_waitcnt vmcnt(3)
  s_barrier
  ds_read_b64_tr_b16 v[28:29], v13 offset:16384
  ds_read_b64_tr_b16 v[30:31], v13 offset:16896
  s_waitcnt lgkmcnt(2)
  v_mfma_f32_32x32x16_bf16 v[48:63], a[76:79], v[40:43], v[48:63]
  ds_read_b64_tr_b16 v[32:33], v14 offset:16384
  ds_read_b64_tr_b16 v[34:35], v14 offset:16896
  buffer_load_dwordx4 v10, s[44:47], s62 offen offset:1024 lds
  v_mfma_f32_32x32x16_bf16 v[64:79], a[76:79], v[44:47], v[64:79]
  ds_read_b64_tr_b16 v[36:37], v13 offset:20480
  ds_read_b64_tr_b16 v[38:39], v13 offset:20992
  s_waitcnt lgkmcnt(2)
  v_mfma_f32_32x32x16_bf16 v[48:63], a[80:83], v[28:31], v[48:63]
  ds_read_b64_tr_b16 v[40:41], v14 offset:20480
  ds_read_b64_tr_b16 v[42:43], v14 offset:20992
  s_add_u32 m0, s88, 49152
  s_nop 0
  buffer_load_dwordx4 v9, s[44:47], s63 offen lds
  ds_read_b128 a[96:99], v5 offset:8192
  v_mfma_f32_32x32x16_bf16 v[64:79], a[80:83], v[32:35], v[64:79]
  ds_read_b64_tr_b16 v[44:45], v13 offset:24576
  ds_read_b64_tr_b16 v[46:47], v13 offset:25088
  ds_read_b128 a[100:103], v6 offset:8192
  s_waitcnt lgkmcnt(4)
  v_mfma_f32_32x32x16_bf16 v[48:63], a[84:87], v[36:39], v[48:63]
  ds_read_b64_tr_b16 v[28:29], v14 offset:24576
  ds_read_b64_tr_b16 v[30:31], v14 offset:25088
  buffer_load_dwordx4 v10, s[44:47], s63 offen offset:1024 lds
  ds_read_b128 a[104:107], v7 offset:8192
  v_mfma_f32_32x32x16_bf16 v[64:79], a[84:87], v[40:43], v[64:79]
  ds_read_b64_tr_b16 v[32:33], v13 offset:28672
  ds_read_b64_tr_b16 v[34:35], v13 offset:29184
  ds_read_b128 a[108:111], v8 offset:8192
  s_waitcnt lgkmcnt(4)
  v_mfma_f32_32x32x16_bf16 v[48:63], a[88:91], v[44:47], v[48:63]
  ds_read_b64_tr_b16 v[36:37], v14 offset:28672
  ds_read_b64_tr_b16 v[38:39], v14 offset:29184
  buffer_load_dwordx2 v[126:127], v23, s[40:43], s99 offen sc1
  v_mfma_f32_32x32x16_bf16 v[64:79], a[88:91], v[28:31], v[64:79]
  s_waitcnt vmcnt(3)
  s_barrier
  ds_read_b64_tr_b16 v[40:41], v13 offset:32768
  ds_read_b64_tr_b16 v[42:43], v13 offset:33280
  s_waitcnt lgkmcnt(2)
  v_mfma_f32_32x32x16_bf16 v[48:63], a[92:95], v[32:35], v[48:63]
  ds_read_b64_tr_b16 v[44:45], v14 offset:32768
  ds_read_b64_tr_b16 v[46:47], v14 offset:33280
  s_cmp_eq_u32 s73, 0
  s_cselect_b64 s[44:45], s[16:17], s[20:21]
  s_mov_b32 s46, s18
  s_mov_b32 s47, 131072
  s_mul_i32 s56, s48, 1792
  s_mul_i32 s57, s49, 1792
  s_mul_i32 s58, s50, 1792
  s_mul_i32 s59, s51, 1792
  s_mul_i32 s60, s52, 1792
  s_mul_i32 s61, s53, 1792
  s_mul_i32 s62, s54, 1792
  s_mul_i32 s63, s55, 1792
  s_add_u32 m0, s88, 0
  s_nop 0
  buffer_load_dwordx4 v11, s[44:47], s56 offen lds
  v_mfma_f32_32x32x16_bf16 v[64:79], a[92:95], v[36:39], v[64:79]
  ds_read_b64_tr_b16 v[28:29], v13 offset:36864
  ds_read_b64_tr_b16 v[30:31], v13 offset:37376
  s_waitcnt lgkmcnt(2)
  v_mfma_f32_32x32x16_bf16 v[48:63], a[96:99], v[40:43], v[48:63]
  ds_read_b64_tr_b16 v[32:33], v14 offset:36864
  ds_read_b64_tr_b16 v[34:35], v14 offset:37376
  buffer_load_dwordx4 v12, s[44:47], s56 offen offset:1024 lds
  ds_read_b128 a[112:115], v5 offset:12288
  s_lshl_b32 s78, s73, 11
  s_lshl_b32 s97, s96, 12
  s_add_u32 s97, s97, s78
  v_mfma_f32_32x32x16_bf16 v[64:79], a[96:99], v[44:47], v[64:79]
  ds_read_b64_tr_b16 v[36:37], v13 offset:40960
  ds_read_b64_tr_b16 v[38:39], v13 offset:41472
  ds_read_b128 a[116:119], v6 offset:12288
  s_waitcnt lgkmcnt(4)
  v_mfma_f32_32x32x16_bf16 v[48:63], a[100:103], v[28:31], v[48:63]
  ds_read_b64_tr_b16 v[40:41], v14 offset:40960
  ds_read_b64_tr_b16 v[42:43], v14 offset:41472
  ds_read_b128 a[120:123], v7 offset:12288
  v_mfma_f32_32x32x16_bf16 v[64:79], a[100:103], v[32:35], v[64:79]
  ds_read_b64_tr_b16 v[44:45], v13 offset:45056
  ds_read_b64_tr_b16 v[46:47], v13 offset:45568
  ds_read_b128 a[124:127], v8 offset:12288
  s_waitcnt lgkmcnt(4)
  v_mfma_f32_32x32x16_bf16 v[48:63], a[104:107], v[36:39], v[48:63]
  ds_read_b64_tr_b16 v[28:29], v14 offset:45056
  ds_read_b64_tr_b16 v[30:31], v14 offset:45568
  v_mfma_f32_32x32x16_bf16 v[64:79], a[104:107], v[40:43], v[64:79]
  s_waitcnt vmcnt(3)
  s_barrier
  ds_read_b64_tr_b16 v[32:33], v13 offset:49152
  ds_read_b64_tr_b16 v[34:35], v13 offset:49664
  s_waitcnt lgkmcnt(2)
  v_mfma_f32_32x32x16_bf16 v[48:63], a[108:111], v[44:47], v[48:63]
  ds_read_b64_tr_b16 v[36:37], v14 offset:49152
  ds_read_b64_tr_b16 v[38:39], v14 offset:49664
  s_add_u32 m0, s88, 16384
  s_nop 0
  buffer_load_dwordx4 v11, s[44:47], s57 offen lds
  v_mfma_f32_32x32x16_bf16 v[64:79], a[108:111], v[28:31], v[64:79]
  ds_read_b64_tr_b16 v[40:41], v13 offset:53248
  ds_read_b64_tr_b16 v[42:43], v13 offset:53760
  s_waitcnt lgkmcnt(2)
  v_mfma_f32_32x32x16_bf16 v[48:63], a[112:115], v[32:35], v[48:63]
  ds_read_b64_tr_b16 v[44:45], v14 offset:53248
  ds_read_b64_tr_b16 v[46:47], v14 offset:53760
  buffer_load_dwordx4 v12, s[44:47], s57 offen offset:1024 lds
  v_mfma_f32_32x32x16_bf16 v[64:79], a[112:115], v[36:39], v[64:79]
  ds_read_b64_tr_b16 v[28:29], v13 offset:57344
  ds_read_b64_tr_b16 v[30:31], v13 offset:57856
  s_waitcnt lgkmcnt(2)
  v_mfma_f32_32x32x16_bf16 v[48:63], a[116:119], v[40:43], v[48:63]
  ds_read_b64_tr_b16 v[32:33], v14 offset:57344
  ds_read_b64_tr_b16 v[34:35], v14 offset:57856
  v_mfma_f32_32x32x16_bf16 v[64:79], a[116:119], v[44:47], v[64:79]
  ds_read_b64_tr_b16 v[36:37], v13 offset:61440
  ds_read_b64_tr_b16 v[38:39], v13 offset:61952
  s_waitcnt lgkmcnt(2)
  v_mfma_f32_32x32x16_bf16 v[48:63], a[120:123], v[28:31], v[48:63]
  ds_read_b64_tr_b16 v[40:41], v14 offset:61440
  ds_read_b64_tr_b16 v[42:43], v14 offset:61952
  s_waitcnt vmcnt(4)
  v_cmp_ne_u32 vcc, 0, v126
  s_mov_b32 s87, 0
  s_cmp_lg_u64 vcc, 0
  s_cbranch_scc1 LC_nonce_done
LC_nonce:
  s_sleep 1
  buffer_load_dwordx2 v[126:127], v23, s[40:43], s99 offen sc1
  s_waitcnt vmcnt(0)
  v_cmp_ne_u32 vcc, 0, v126
  s_add_u32 s87, s87, 1
  s_cmp_ge_u32 s87, 262144
  s_cbranch_scc1 LC_nonce_done
  s_cmp_eq_u64 vcc, 0
  s_cbranch_scc1 LC_nonce
LC_nonce_done:
  s_nop 0
  v_readfirstlane_b32 s82, v126
  v_readfirstlane_b32 s83, v127
  s_nop 3
  v_mfma_f32_32x32x16_bf16 v[64:79], a[120:123], v[32:35], v[64:79]
  s_waitcnt vmcnt(2)
  s_barrier
  s_or_b32 s77, s4, s3
  s_cmp_lg_u32 s77, 0
  s_cbranch_scc1 LC_zflag
  v_mov_b32 v24, 0
  v_mov_b32 v26, s82
  v_mov_b32 v27, s83
  s_mov_b64 exec, 1
  buffer_store_dwordx2 v[26:27], v24, s[32:35], s2 offen offset:24 sc1
  s_mov_b64 exec, -1
LC_zflag:
  s_nop 0
  ds_read_b64_tr_b16 v[44:45], v17
  ds_read_b64_tr_b16 v[46:47], v17 offset:512
  s_waitcnt lgkmcnt(2)
  v_mfma_f32_32x32x16_bf16 v[48:63], a[124:127], v[36:39], v[48:63]
  ds_read_b64_tr_b16 v[28:29], v18
  ds_read_b64_tr_b16 v[30:31], v18 offset:512
  s_add_u32 m0, s88, 32768
  s_nop 0
  buffer_load_dwordx4 v11, s[44:47], s58 offen lds
  v_mfma_f32_32x32x16_bf16 v[64:79], a[124:127], v[40:43], v[64:79]
  ds_read_b64_tr_b16 v[32:33], v17 offset:4096
  ds_read_b64_tr_b16 v[34:35], v17 offset:4608
  s_waitcnt lgkmcnt(2)
  v_mfma_f32_32x32x16_bf16 v[80:95], v[44:47], a[0:3], 0
  ds_read_b64_tr_b16 v[36:37], v18 offset:4096
  ds_read_b64_tr_b16 v[38:39], v18 offset:4608
  buffer_load_dwordx4 v12, s[44:47], s58 offen offset:1024 lds
  v_mfma_f32_32x32x16_bf16 v[96:111], v[28:31], a[0:3], 0
  ds_read_b64_tr_b16 v[40:41], v17 offset:8192
  ds_read_b64_tr_b16 v[42:43], v17 offset:8704
  s_waitcnt lgkmcnt(2)
  v_mfma_f32_32x32x16_bf16 v[80:95], v[32:35], a[4:7], v[80:95]
  ds_read_b64_tr_b16 v[44:45], v18 offset:8192
  ds_read_b64_tr_b16 v[46:47], v18 offset:8704
  v_lshlrev_b32 v24, 7, v1
  s_mul_i32 s77, s90, 7168
  s_add_u32 s77, s77, 0
  s_mov_b32 exec_lo, 0xff
  s_mov_b32 exec_hi, 0x0
  buffer_load_dword v23, v24, s[24:27], s77 offen
  s_mov_b64 exec, -1
  v_mfma_f32_32x32x16_bf16 v[96:111], v[36:39], a[4:7], v[96:111]
  ds_read_b64_tr_b16 v[28:29], v17 offset:12288
  ds_read_b64_tr_b16 v[30:31], v17 offset:12800
  v_cvt_pk_bf16_f32 v64, v64, v65
  v_cvt_pk_bf16_f32 v65, v66, v67
  v_cvt_pk_bf16_f32 v66, v68, v69
  v_cvt_pk_bf16_f32 v67, v70, v71
  v_cvt_pk_bf16_f32 v68, v72, v73
  s_waitcnt lgkmcnt(2)
  v_mfma_f32_32x32x16_bf16 v[80:95], v[40:43], a[8:11], v[80:95]
  ds_read_b64_tr_b16 v[32:33], v18 offset:12288
  ds_read_b64_tr_b16 v[34:35], v18 offset:12800
  v_cvt_pk_bf16_f32 v69, v74, v75
  v_cvt_pk_bf16_f32 v70, v76, v77
  v_cvt_pk_bf16_f32 v71, v78, v79
  v_mul_f32 v72, s74, v48
  v_mfma_f32_32x32x16_bf16 v[96:111], v[44:47], a[8:11], v[96:111]
  s_waitcnt vmcnt(3)
  s_barrier
  ds_read_b64_tr_b16 v[36:37], v17 offset:16384
  ds_read_b64_tr_b16 v[38:39], v17 offset:16896
  v_mul_f32 v73, s74, v49
  v_mul_f32 v74, s74, v50
  v_mul_f32 v75, s74, v51
  v_exp_f32_e64 v72, v72 clamp
  v_exp_f32_e64 v73, v73 clamp
  s_waitcnt lgkmcnt(2)
  v_mfma_f32_32x32x16_bf16 v[80:95], v[28:31], a[12:15], v[80:95]
  ds_read_b64_tr_b16 v[40:41], v18 offset:16384
  ds_read_b64_tr_b16 v[42:43], v18 offset:16896
  s_add_u32 m0, s88, 49152
  s_nop 0
  buffer_load_dwordx4 v11, s[44:47], s59 offen lds
  v_exp_f32_e64 v74, v74 clamp
  v_exp_f32_e64 v75, v75 clamp
  v_max_f32 v48, s76, v48
  v_max_f32 v49, s76, v49
  v_mfma_f32_32x32x16_bf16 v[96:111], v[32:35], a[12:15], v[96:111]
  ds_read_b64_tr_b16 v[44:45], v17 offset:20480
  ds_read_b64_tr_b16 v[46:47], v17 offset:20992
  v_max_f32 v50, s76, v50
  v_max_f32 v51, s76, v51
  v_add_f32 v48, v72, v48
  v_add_f32 v49, v73, v49
  v_add_f32 v50, v74, v50
  s_waitcnt lgkmcnt(2)
  v_mfma_f32_32x32x16_bf16 v[80:95], v[36:39], a[16:19], v[80:95]
  ds_read_b64_tr_b16 v[28:29], v18 offset:20480
  ds_read_b64_tr_b16 v[30:31], v18 offset:20992
  buffer_load_dwordx4 v12, s[44:47], s59 offen offset:1024 lds
  v_and_b32 v26, 3, v1
  v_and_b32 v27, 1, v26
  v_lshrrev_b32 v25, 1, v26
  v_lshl_or_b32 v27, v27, 1, v25
  v_lshlrev_b32 v24, 7, v21
  v_bfe_u32 v25, v1, 4, 1
  s_lshl_b32 s77, s73, 1
  v_lshl_add_u32 v27, v27, 3, v24
  v_lshl_add_u32 v24, v26, 3, v24
  v_bfe_u32 v26, v1, 3, 1
  v_lshl_or_b32 v26, v26, 1, v25
  v_xor_b32 v26, s77, v26
  v_lshl_add_u32 v13, v26, 5, v24
  v_add_u32 v15, 65536, v13
  v_add_f32 v51, v75, v51
  v_mul_f32 v76, s74, v52
  v_mul_f32 v77, s74, v53
  v_mul_f32 v78, s74, v54
  v_mfma_f32_32x32x16_bf16 v[96:111], v[40:43], a[16:19], v[96:111]
  ds_read_b64_tr_b16 v[32:33], v17 offset:24576
  ds_read_b64_tr_b16 v[34:35], v17 offset:25088
  v_mul_f32 v79, s74, v55
  v_exp_f32_e64 v76, v76 clamp
  v_exp_f32_e64 v77, v77 clamp
  v_exp_f32_e64 v78, v78 clamp
  v_exp_f32_e64 v79, v79 clamp
  s_waitcnt lgkmcnt(2)
  v_mfma_f32_32x32x16_bf16 v[80:95], v[44:47], a[20:23], v[80:95]
  ds_read_b64_tr_b16 v[36:37], v18 offset:24576
  ds_read_b64_tr_b16 v[38:39], v18 offset:25088
  v_lshlrev_b32 v24, 7, v1
  s_mul_i32 s77, s90, 7168
  s_add_u32 s77, s77, 1024
  s_mov_b32 exec_lo, 0xff
  s_mov_b32 exec_hi, 0x0
  buffer_load_dword v23, v24, s[24:27], s77 offen
  s_mov_b64 exec, -1
  s_mul_i32 s77, s72, 49152
  s_lshl_b32 s78, s95, 1
  s_add_u32 s78, s78, s96
  s_lshl_b32 s78, s78, 7
  s_add_u32 s77, s77, s78
  s_mul_i32 s78, s73, 24576
  s_add_u32 s77, s77, s78
  v_lshrrev_b32 v24, 3, v1
  v_mul_u32_u24 v24, 3072, v24
  v_and_b32 v25, 1, v1
  v_lshl_add_u32 v24, v25, 4, v24
  v_add_u32 v24, s77, v24
  v_bfe_u32 v25, v1, 1, 2
  v_bfe_u32 v26, v1, 4, 1
  v_lshlrev_b32 v26, 1, v26
  v_xor_b32 v25, v25, v26
  v_lshl_add_u32 v9, v25, 5, v24
  v_max_f32 v52, s76, v52
  v_max_f32 v53, s76, v53
  v_max_f32 v54, s76, v54
  v_max_f32 v55, s76, v55
  v_mfma_f32_32x32x16_bf16 v[96:111], v[28:31], a[20:23], v[96:111]
  ds_read_b64_tr_b16 v[40:41], v17 offset:28672
  ds_read_b64_tr_b16 v[42:43], v17 offset:29184
  v_add_f32 v52, v76, v52
  v_add_f32 v53, v77, v53
  v_add_f32 v54, v78, v54
  v_add_f32 v55, v79, v55
  v_mul_f32 v72, s74, v56
  s_waitcnt lgkmcnt(2)
  v_mfma_f32_32x32x16_bf16 v[80:95], v[32:35], a[24:27], v[80:95]
  ds_read_b64_tr_b16 v[44:45], v18 offset:28672
  ds_read_b64_tr_b16 v[46:47], v18 offset:29184
  v_mul_f32 v73, s74, v57
  v_mul_f32 v74, s74, v58
  v_mul_f32 v75, s74, v59
  v_exp_f32_e64 v72, v72 clamp
  v_mfma_f32_32x32x16_bf16 v[96:111], v[36:39], a[24:27], v[96:111]
  s_waitcnt vmcnt(4)
  s_barrier
  ds_read_b64_tr_b16 v[28:29], v17 offset:32768
  ds_read_b64_tr_b16 v[30:31], v17 offset:33280
  v_exp_f32_e64 v73, v73 clamp
  v_exp_f32_e64 v74, v74 clamp
  v_exp_f32_e64 v75, v75 clamp
  v_max_f32 v56, s76, v56
  v_max_f32 v57, s76, v57
  s_waitcnt lgkmcnt(2)
  v_mfma_f32_32x32x16_bf16 v[80:95], v[40:43], a[28:31], v[80:95]
  ds_read_b64_tr_b16 v[32:33], v18 offset:32768
  ds_read_b64_tr_b16 v[34:35], v18 offset:33280
  s_add_u32 m0, s88, 0
  s_nop 0
  buffer_load_dwordx4 v11, s[44:47], s60 offen lds
  v_max_f32 v58, s76, v58
  v_max_f32 v59, s76, v59
  v_add_f32 v56, v72, v56
  v_add_f32 v57, v73, v57
  v_mfma_f32_32x32x16_bf16 v[96:111], v[44:47], a[28:31], v[96:111]
  ds_read_b64_tr_b16 v[36:37], v17 offset:36864
  ds_read_b64_tr_b16 v[38:39], v17 offset:37376
  v_add_f32 v58, v74, v58
  v_add_f32 v59, v75, v59
  v_mul_f32 v76, s74, v60
  v_mul_f32 v77, s74, v61
  v_mul_f32 v78, s74, v62
  s_waitcnt lgkmcnt(2)
  v_mfma_f32_32x32x16_bf16 v[80:95], v[28:31], a[32:35], v[80:95]
  ds_read_b64_tr_b16 v[40:41], v18 offset:36864
  ds_read_b64_tr_b16 v[42:43], v18 offset:37376
  buffer_load_dwordx4 v12, s[44:47], s60 offen offset:1024 lds
  v_mul_f32 v79, s74, v63
  v_exp_f32_e64 v76, v76 clamp
  v_exp_f32_e64 v77, v77 clamp
  v_exp_f32_e64 v78, v78 clamp
  v_mfma_f32_32x32x16_bf16 v[96:111], v[32:35], a[32:35], v[96:111]
  ds_read_b64_tr_b16 v[44:45], v17 offset:40960
  ds_read_b64_tr_b16 v[46:47], v17 offset:41472
  v_exp_f32_e64 v79, v79 clamp
  v_max_f32 v60, s76, v60
  v_max_f32 v61, s76, v61
  v_max_f32 v62, s76, v62
  v_max_f32 v63, s76, v63
  s_waitcnt lgkmcnt(2)
  v_mfma_f32_32x32x16_bf16 v[80:95], v[36:39], a[36:39], v[80:95]
  ds_read_b64_tr_b16 v[28:29], v18 offset:40960
  ds_read_b64_tr_b16 v[30:31], v18 offset:41472
  v_lshlrev_b32 v24, 7, v1
  s_mul_i32 s77, s90, 7168
  s_add_u32 s77, s77, 2048
  s_mov_b32 exec_lo, 0xff
  s_mov_b32 exec_hi, 0x0
  buffer_load_dword v23, v24, s[24:27], s77 offen
  s_mov_b64 exec, -1
  v_add_f32 v60, v76, v60
  v_add_f32 v61, v77, v61
  v_add_f32 v62, v78, v62
  v_add_f32 v63, v79, v63
  v_mfma_f32_32x32x16_bf16 v[96:111], v[40:43], a[36:39], v[96:111]
  ds_read_b64_tr_b16 v[32:33], v17 offset:45056
  ds_read_b64_tr_b16 v[34:35], v17 offset:45568
  v_cvt_pk_bf16_f32 v48, v48, v49
  v_cvt_pk_bf16_f32 v49, v50, v51
  v_cvt_pk_bf16_f32 v50, v52, v53
  v_cvt_pk_bf16_f32 v51, v54, v55
  v_cvt_pk_bf16_f32 v52, v56, v57
  s_waitcnt lgkmcnt(2)
  v_mfma_f32_32x32x16_bf16 v[80:95], v[44:47], a[40:43], v[80:95]
  ds_read_b64_tr_b16 v[36:37], v18 offset:45056
  ds_read_b64_tr_b16 v[38:39], v18 offset:45568
  v_cvt_pk_bf16_f32 v53, v58, v59
  v_cvt_pk_bf16_f32 v54, v60, v61
  v_cvt_pk_bf16_f32 v55, v62, v63
  v_mov_b32 v24, 1065369472
  v_mov_b32 v25, 1065369472
  v_mov_b32 v26, 1065369472
  v_mov_b32 v27, 1065369472
  s_nop 1
  v_mfma_f32_32x32x16_bf16 v[112:127], v[48:51], v[24:27], 0
  v_mfma_f32_32x32x16_bf16 v[112:127], v[52:55], v[24:27], v[112:127]
  v_mfma_f32_32x32x16_bf16 v[96:111], v[28:31], a[40:43], v[96:111]
  s_waitcnt vmcnt(4)
  s_barrier
  ds_read_b64_tr_b16 v[40:41], v17 offset:49152
  ds_read_b64_tr_b16 v[42:43], v17 offset:49664
  s_waitcnt lgkmcnt(2)
  v_mfma_f32_32x32x16_bf16 v[80:95], v[32:35], a[44:47], v[80:95]
  ds_read_b64_tr_b16 v[44:45], v18 offset:49152
  ds_read_b64_tr_b16 v[46:47], v18 offset:49664
  s_add_u32 m0, s88, 16384
  s_nop 0
  buffer_load_dwordx4 v11, s[44:47], s61 offen lds
  v_cndmask_b32 v56, v120, v112, s[80:81]
  v_cndmask_b32 v57, v121, v113, s[80:81]
  v_cndmask_b32 v58, v122, v114, s[80:81]
  v_cndmask_b32 v59, v123, v115, s[80:81]
  v_mfma_f32_32x32x16_bf16 v[96:111], v[36:39], a[44:47], v[96:111]
  ds_read_b64_tr_b16 v[28:29], v17 offset:53248
  ds_read_b64_tr_b16 v[30:31], v17 offset:53760
  v_cndmask_b32 v60, v124, v116, s[80:81]
  v_cndmask_b32 v61, v125, v117, s[80:81]
  v_cndmask_b32 v62, v126, v118, s[80:81]
  v_cndmask_b32 v63, v127, v119, s[80:81]
  v_mfma_f32_32x32x16_bf16 v[112:127], v[48:51], v[64:67], 0
  s_waitcnt lgkmcnt(2)
  v_mfma_f32_32x32x16_bf16 v[80:95], v[40:43], a[48:51], v[80:95]
  ds_read_b64_tr_b16 v[32:33], v18 offset:53248
  ds_read_b64_tr_b16 v[34:35], v18 offset:53760
  buffer_load_dwordx4 v12, s[44:47], s61 offen offset:1024 lds
  v_mfma_f32_32x32x16_bf16 v[112:127], v[52:55], v[68:71], v[112:127]
  s_lshl_b32 s77, s3, 12
  s_add_u32 s77, s77, 65536
  v_add_u32 v22, s77, v2
  ds_write_b128 v22, v[56:59] offset:2048
  ds_write_b128 v22, v[60:63] offset:3072
  v_mfma_f32_32x32x16_bf16 v[96:111], v[44:47], a[48:51], v[96:111]
  ds_read_b64_tr_b16 v[36:37], v17 offset:57344
  ds_read_b64_tr_b16 v[38:39], v17 offset:57856
  s_nop 3
  v_cndmask_b32 v72, v112, v120, s[80:81]
  v_cndmask_b32 v73, v113, v121, s[80:81]
  s_waitcnt lgkmcnt(4)
  v_mfma_f32_32x32x16_bf16 v[80:95], v[28:31], a[52:55], v[80:95]
  ds_read_b64_tr_b16 v[40:41], v18 offset:57344
  ds_read_b64_tr_b16 v[42:43], v18 offset:57856
  v_lshlrev_b32 v24, 7, v1
  s_mul_i32 s77, s90, 7168
  s_add_u32 s77, s77, 3072
  s_mov_b32 exec_lo, 0xff
  s_mov_b32 exec_hi, 0x0
  buffer_load_dword v23, v24, s[24:27], s77 offen
  s_mov_b64 exec, -1
  v_cndmask_b32 v74, v114, v122, s[80:81]
  v_cndmask_b32 v75, v115, v123, s[80:81]
  v_cndmask_b32 v76, v116, v124, s[80:81]
  v_cndmask_b32 v77, v117, v125, s[80:81]
  v_mfma_f32_32x32x16_bf16 v[96:111], v[32:35], a[52:55], v[96:111]
  ds_read_b64_tr_b16 v[44:45], v17 offset:61440
  ds_read_b64_tr_b16 v[46:47], v17 offset:61952
  v_cndmask_b32 v78, v118, v126, s[80:81]
  v_cndmask_b32 v79, v119, v127, s[80:81]
  ds_write_b128 v22, v[72:75]
  ds_write_b128 v22, v[76:79] offset:1024
  s_waitcnt lgkmcnt(4)
  v_mfma_f32_32x32x16_bf16 v[80:95], v[36:39], a[56:59], v[80:95]
  ds_read_b64_tr_b16 v[28:29], v18 offset:61440
  ds_read_b64_tr_b16 v[30:31], v18 offset:61952
  v_mfma_f32_32x32x16_bf16 v[96:111], v[40:43], a[56:59], v[96:111]
  s_waitcnt vmcnt(4) lgkmcnt(2)
  s_barrier
  ds_read_b64_tr_b16 v[32:33], v17
  ds_read_b64_tr_b16 v[34:35], v17 offset:512
  s_waitcnt lgkmcnt(2)
  v_mfma_f32_32x32x16_bf16 v[80:95], v[44:47], a[60:63], v[80:95]
  ds_read_b64_tr_b16 v[36:37], v18
  ds_read_b64_tr_b16 v[38:39], v18 offset:512
  s_add_u32 m0, s88, 32768
  s_nop 0
  buffer_load_dwordx4 v11, s[44:47], s62 offen lds
  s_lshl_b32 s77, s73, 14
  s_lshl_b32 s78, s72, 10
  s_add_u32 s77, s77, s78
  s_add_u32 s77, s77, 65536
  v_add_u32 v48, s77, v2
  ds_read_b128 v[112:115], v48
  v_mfma_f32_32x32x16_bf16 v[96:111], v[28:31], a[60:63], v[96:111]
  ds_read_b64_tr_b16 v[40:41], v17 offset:4096
  ds_read_b64_tr_b16 v[42:43], v17 offset:4608
  ds_read_b128 v[116:119], v48 offset:4096
  s_waitcnt lgkmcnt(4)
  v_mfma_f32_32x32x16_bf16 v[80:95], v[32:35], a[64:67], v[80:95]
  ds_read_b64_tr_b16 v[44:45], v18 offset:4096
  ds_read_b64_tr_b16 v[46:47], v18 offset:4608
  buffer_load_dwordx4 v12, s[44:47], s62 offen offset:1024 lds
  ds_read_b128 v[120:123], v48 offset:8192
  ds_read_b128 v[124:127], v48 offset:12288
  v_mfma_f32_32x32x16_bf16 v[96:111], v[36:39], a[64:67], v[96:111]
  ds_read_b64_tr_b16 v[28:29], v17 offset:8192
  ds_read_b64_tr_b16 v[30:31], v17 offset:8704
  s_lshl_b32 s77, s95, 1
  s_add_u32 s77, s77, s96
  s_lshl_b32 s77, s77, 1
  s_add_u32 s77, s77, s73
  s_lshl_b32 s77, s77, 2
  s_add_u32 s77, s77, s72
  s_lshl_b32 s77, s77, 10
  s_add_u32 s77, s77, 10485760
  s_cmp_lt_u32 s72, 2
  s_cselect_b32 s78, 0, 4
  s_mov_b32 s85, 65537
  s_cselect_b32 s0, -1, s85
  s_mov_b32 s1, s0
  v_lshrrev_b32 v24, s78, v1
  v_lshlrev_b32 v24, 2, v24
  v_add_u32 v49, s77, v24
  s_lshl_b32 s77, s5, 7
  s_add_u32 s77, s77, 11599872
  v_mov_b32 v52, s77
  buffer_load_dwordx2 v[50:51], v52, s[32:35], 0 offen offset:24 sc1
  s_waitcnt lgkmcnt(4)
  v_mfma_f32_32x32x16_bf16 v[80:95], v[40:43], a[68:71], v[80:95]
  ds_read_b64_tr_b16 v[32:33], v18 offset:8192
  ds_read_b64_tr_b16 v[34:35], v18 offset:8704
  v_lshlrev_b32 v24, 7, v1
  s_mul_i32 s77, s90, 7168
  s_add_u32 s77, s77, 4096
  s_mov_b32 exec_lo, 0xff
  s_mov_b32 exec_hi, 0x0
  buffer_load_dword v23, v24, s[24:27], s77 offen
  s_mov_b64 exec, -1
  v_mfma_f32_32x32x16_bf16 v[96:111], v[44:47], a[68:71], v[96:111]
  ds_read_b64_tr_b16 v[36:37], v17 offset:12288
  ds_read_b64_tr_b16 v[38:39], v17 offset:12800
  s_waitcnt lgkmcnt(2)
  v_mfma_f32_32x32x16_bf16 v[80:95], v[28:31], a[72:75], v[80:95]
  ds_read_b64_tr_b16 v[40:41], v18 offset:12288
  ds_read_b64_tr_b16 v[42:43], v18 offset:12800
  v_add_f32 v112, v112, v116
  v_add_f32 v120, v120, v124
  v_add_f32 v113, v113, v117
  v_add_f32 v121, v121, v125
  v_add_f32 v114, v114, v118
  v_add_f32 v122, v122, v126
  v_add_f32 v115, v115, v119
  v_add_f32 v123, v123, v127
  v_add_f32 v112, v112, v120
  v_add_f32 v113, v113, v121
  v_add_f32 v114, v114, v122
  v_add_f32 v115, v115, v123
  v_mfma_f32_32x32x16_bf16 v[96:111], v[32:35], a[72:75], v[96:111]
  s_waitcnt vmcnt(5)
  s_barrier
  ds_read_b64_tr_b16 v[44:45], v17 offset:16384
  ds_read_b64_tr_b16 v[46:47], v17 offset:16896
  s_waitcnt lgkmcnt(2)
  v_mfma_f32_32x32x16_bf16 v[80:95], v[36:39], a[76:79], v[80:95]
  ds_read_b64_tr_b16 v[28:29], v18 offset:16384
  ds_read_b64_tr_b16 v[30:31], v18 offset:16896
  s_add_u32 m0, s88, 49152
  s_nop 0
  buffer_load_dwordx4 v11, s[44:47], s63 offen lds
  v_mfma_f32_32x32x16_bf16 v[96:111], v[40:43], a[76:79], v[96:111]
  ds_read_b64_tr_b16 v[32:33], v17 offset:20480
  ds_read_b64_tr_b16 v[34:35], v17 offset:20992
  s_waitcnt lgkmcnt(2)
  v_mfma_f32_32x32x16_bf16 v[80:95], v[44:47], a[80:83], v[80:95]
  ds_read_b64_tr_b16 v[36:37], v18 offset:20480
  ds_read_b64_tr_b16 v[38:39], v18 offset:20992
  buffer_load_dwordx4 v12, s[44:47], s63 offen offset:1024 lds
  v_mfma_f32_32x32x16_bf16 v[96:111], v[28:31], a[80:83], v[96:111]
  ds_read_b64_tr_b16 v[40:41], v17 offset:24576
  ds_read_b64_tr_b16 v[42:43], v17 offset:25088
  s_waitcnt lgkmcnt(2)
  v_mfma_f32_32x32x16_bf16 v[80:95], v[32:35], a[84:87], v[80:95]
  ds_read_b64_tr_b16 v[44:45], v18 offset:24576
  ds_read_b64_tr_b16 v[46:47], v18 offset:25088
  v_lshlrev_b32 v24, 7, v1
  s_mul_i32 s77, s90, 7168
  s_add_u32 s77, s77, 5120
  s_mov_b32 exec_lo, 0xff
  s_mov_b32 exec_hi, 0x0
  buffer_load_dword v23, v24, s[24:27], s77 offen
  s_mov_b64 exec, -1
  v_lshrrev_b32 v24, 3, v1
  v_and_b32 v25, 7, v1
  v_bfe_u32 v26, v1, 4, 1
  v_lshlrev_b32 v26, 2, v26
  v_xor_b32 v25, v25, v26
  v_lshlrev_b32 v25, 4, v25
  v_lshl_add_u32 v24, v24, 10, v25
  s_lshl_b32 s77, s73, 13
  s_lshl_b32 s78, s7, 7
  s_add_u32 s77, s77, s78
  v_add_u32 v3, s77, v24
  v_lshlrev_b32 v24, 7, v21
  v_and_b32 v25, 1, v1
  v_lshl_add_u32 v24, v25, 3, v24
  s_lshl_b32 s77, s72, 13
  v_add_u32 v24, s77, v24
  v_bfe_u32 v25, v1, 1, 1
  v_bfe_u32 v26, v1, 4, 1
  v_lshl_or_b32 v25, v26, 1, v25
  v_bfe_u32 v26, v1, 3, 1
  v_lshl_or_b32 v25, v26, 2, v25
  v_lshl_add_u32 v5, v25, 4, v24
  v_xor_b32 v25, 4, v25
  v_lshl_add_u32 v6, v25, 4, v24
  v_add_u32 v7, 65536, v5
  v_add_u32 v8, 65536, v6
  v_add_u32 v4, 131072, v5
  v_add_u32 v21, 131072, v6
  s_lshl_b32 s89, s72, 13
  s_lshl_b32 s77, s73, 10
  s_add_u32 s89, s89, s77
  s_mul_i32 s92, s72, 458752
  s_lshl_b32 s93, s72, 17
  s_and_b32 s91, s6, 3
  s_lshl_b32 s91, s91, 1
  s_add_u32 s91, s91, s7
  s_and_b32 s91, s91, 7
  s_xor_b32 s64, s91, 0
  s_lshl_b32 s64, s64, 14
  s_xor_b32 s65, s91, 1
  s_lshl_b32 s65, s65, 14
  s_xor_b32 s66, s91, 2
  s_lshl_b32 s66, s66, 14
  s_xor_b32 s67, s91, 3
  s_lshl_b32 s67, s67, 14
  s_xor_b32 s68, s91, 4
  s_lshl_b32 s68, s68, 14
  s_xor_b32 s69, s91, 5
  s_lshl_b32 s69, s69, 14
  s_xor_b32 s70, s91, 6
  s_lshl_b32 s70, s70, 14
  s_xor_b32 s71, s91, 7
  s_lshl_b32 s71, s71, 14
  s_lshl_b32 s77, s6, 1
  s_add_u32 s77, s77, s73
  s_mul_i32 s86, s77, 144
  s_mul_i32 s78, s72, 36
  s_add_u32 s86, s86, s78
  s_lshl_b32 s86, s86, 10
  v_mfma_f32_32x32x16_bf16 v[96:111], v[36:39], a[84:87], v[96:111]
  ds_read_b64_tr_b16 v[28:29], v17 offset:28672
  ds_read_b64_tr_b16 v[30:31], v17 offset:29184
  s_waitcnt lgkmcnt(2)
  v_mfma_f32_32x32x16_bf16 v[80:95], v[40:43], a[88:91], v[80:95]
  ds_read_b64_tr_b16 v[32:33], v18 offset:28672
  ds_read_b64_tr_b16 v[34:35], v18 offset:29184
  s_waitcnt vmcnt(4)
  v_cmp_ne_u64 vcc, s[82:83], v[50:51]
  s_mov_b32 s87, 0
  s_cmp_eq_u64 vcc, 0
  s_cbranch_scc1 LC_zpoll_done
LC_zpoll:
  s_sleep 1
  buffer_load_dwordx2 v[50:51], v52, s[32:35], 0 offen offset:24 sc1
  s_waitcnt vmcnt(0)
  v_cmp_ne_u64 vcc, s[82:83], v[50:51]
  s_add_u32 s87, s87, 1
  s_cmp_ge_u32 s87, 262144
  s_cbranch_scc1 LC_zpoll_done
  s_cmp_eq_u64 vcc, 0
  s_cbranch_scc0 LC_zpoll
LC_zpoll_done:
  s_nop 0
  s_mov_b64 exec, s[0:1]
  buffer_atomic_add_f32 v112, v49, s[32:35], 0 offen
  buffer_atomic_add_f32 v113, v49, s[32:35], 0 offen offset:256
  buffer_atomic_add_f32 v114, v49, s[32:35], 0 offen offset:512
  buffer_atomic_add_f32 v115, v49, s[32:35], 0 offen offset:768
  s_mov_b64 exec, -1
  v_mfma_f32_32x32x16_bf16 v[96:111], v[44:47], a[88:91], v[96:111]
  s_barrier
  ds_read_b64_tr_b16 v[36:37], v17 offset:32768
  ds_read_b64_tr_b16 v[38:39], v17 offset:33280
  s_waitcnt lgkmcnt(2)
  v_mfma_f32_32x32x16_bf16 v[80:95], v[28:31], a[92:95], v[80:95]
  ds_read_b64_tr_b16 v[40:41], v18 offset:32768
  ds_read_b64_tr_b16 v[42:43], v18 offset:33280
  s_mov_b32 s44, s12
  s_mov_b32 s45, s13
  s_mov_b32 s46, s14
  s_mov_b32 s47, 131072
  s_mul_i32 s56, s48, 1536
  s_mul_i32 s57, s49, 1536
  s_mul_i32 s58, s50, 1536
  s_mul_i32 s59, s51, 1536
  s_mul_i32 s60, s52, 1536
  s_mul_i32 s61, s53, 1536
  s_mul_i32 s62, s54, 1536
  s_mul_i32 s63, s55, 1536
  s_lshl_b32 s77, s73, 10
  s_sub_u32 s88, s88, s77
  s_add_u32 m0, s88, 0
  s_nop 0
  buffer_load_dwordx4 v9, s[44:47], s56 offen lds
  v_mfma_f32_32x32x16_bf16 v[96:111], v[32:35], a[92:95], v[96:111]
  ds_read_b64_tr_b16 v[44:45], v17 offset:36864
  ds_read_b64_tr_b16 v[46:47], v17 offset:37376
  s_waitcnt lgkmcnt(2)
  v_mfma_f32_32x32x16_bf16 v[80:95], v[36:39], a[96:99], v[80:95]
  ds_read_b64_tr_b16 v[28:29], v18 offset:36864
  ds_read_b64_tr_b16 v[30:31], v18 offset:37376
  v_lshlrev_b32 v24, 7, v1
  s_mul_i32 s77, s90, 7168
  s_add_u32 s77, s77, 6144
  s_mov_b32 exec_lo, 0xff
  s_mov_b32 exec_hi, 0x0
  buffer_load_dword v23, v24, s[24:27], s77 offen
  s_mov_b64 exec, -1
  v_mfma_f32_32x32x16_bf16 v[96:111], v[40:43], a[96:99], v[96:111]
  ds_read_b64_tr_b16 v[32:33], v17 offset:40960
  ds_read_b64_tr_b16 v[34:35], v17 offset:41472
  v_mov_b32 v64, s76
  v_mov_b32 v65, s76
  s_waitcnt lgkmcnt(2)
  v_mfma_f32_32x32x16_bf16 v[80:95], v[44:47], a[100:103], v[80:95]
  ds_read_b64_tr_b16 v[36:37], v18 offset:40960
  ds_read_b64_tr_b16 v[38:39], v18 offset:41472
  s_add_u32 m0, s89, 131072
  s_add_u32 s85, s64, s92
  buffer_load_dwordx4 v3, s[24:27], s85 offen lds
  v_mov_b32 v66, s76
  v_mfma_f32_32x32x16_bf16 v[96:111], v[28:31], a[100:103], v[96:111]
  ds_read_b64_tr_b16 v[40:41], v17 offset:45056
  ds_read_b64_tr_b16 v[42:43], v17 offset:45568
  v_mov_b32 v67, s76
  v_mov_b32 v68, s76
  s_waitcnt lgkmcnt(2)
  v_mfma_f32_32x32x16_bf16 v[80:95], v[32:35], a[104:107], v[80:95]
  ds_read_b64_tr_b16 v[44:45], v18 offset:45056
  ds_read_b64_tr_b16 v[46:47], v18 offset:45568
  s_add_u32 m0, s89, 133120
  s_add_u32 s85, s65, s92
  buffer_load_dwordx4 v3, s[24:27], s85 offen lds
  v_mov_b32 v69, s76
  v_mfma_f32_32x32x16_bf16 v[96:111], v[36:39], a[104:107], v[96:111]
  s_waitcnt vmcnt(4)
  s_barrier
  s_cmp_lg_u32 s3, 0
  s_cbranch_scc1 LC_kvflag
  v_mov_b32 v24, 0
  v_mov_b32 v26, s82
  v_mov_b32 v27, s83
  s_mov_b64 exec, 1
  buffer_store_dwordx2 v[26:27], v24, s[32:35], s2 offen sc1
  s_mov_b64 exec, -1
LC_kvflag:
  s_nop 0
  ds_read_b64_tr_b16 v[28:29], v17 offset:49152
  ds_read_b64_tr_b16 v[30:31], v17 offset:49664
  v_mov_b32 v70, s76
  v_mov_b32 v71, s76
  s_waitcnt lgkmcnt(2)
  v_mfma_f32_32x32x16_bf16 v[80:95], v[40:43], a[108:111], v[80:95]
  ds_read_b64_tr_b16 v[32:33], v18 offset:49152
  ds_read_b64_tr_b16 v[34:35], v18 offset:49664
  s_add_u32 m0, s89, 135168
  s_add_u32 s85, s66, s92
  buffer_load_dwordx4 v3, s[24:27], s85 offen lds
  v_mov_b32 v72, s76
  v_mfma_f32_32x32x16_bf16 v[96:111], v[44:47], a[108:111], v[96:111]
  ds_read_b64_tr_b16 v[36:37], v17 offset:53248
  ds_read_b64_tr_b16 v[38:39], v17 offset:53760
  v_mov_b32 v73, s76
  v_mov_b32 v74, s76
  s_waitcnt lgkmcnt(2)
  v_mfma_f32_32x32x16_bf16 v[80:95], v[28:31], a[112:115], v[80:95]
  ds_read_b64_tr_b16 v[40:41], v18 offset:53248
  ds_read_b64_tr_b16 v[42:43], v18 offset:53760
  s_add_u32 m0, s89, 137216
  s_add_u32 s85, s67, s92
  buffer_load_dwordx4 v3, s[24:27], s85 offen lds
  v_mov_b32 v11, v49
  v_mov_b32 v75, s76
  v_mfma_f32_32x32x16_bf16 v[96:111], v[32:35], a[112:115], v[96:111]
  ds_read_b64_tr_b16 v[44:45], v17 offset:57344
  ds_read_b64_tr_b16 v[46:47], v17 offset:57856
  v_mov_b32 v76, s76
  v_mov_b32 v77, s76
  s_waitcnt lgkmcnt(2)
  v_mfma_f32_32x32x16_bf16 v[80:95], v[36:39], a[116:119], v[80:95]
  ds_read_b64_tr_b16 v[28:29], v18 offset:57344
  ds_read_b64_tr_b16 v[30:31], v18 offset:57856
  s_add_u32 m0, s88, 16384
  s_nop 0
  buffer_load_dwordx4 v9, s[44:47], s57 offen lds
  v_mov_b32 v78, s76
  v_mfma_f32_32x32x16_bf16 v[96:111], v[40:43], a[116:119], v[96:111]
  ds_read_b64_tr_b16 v[32:33], v17 offset:61440
  ds_read_b64_tr_b16 v[34:35], v17 offset:61952
  v_mov_b32 v79, s76
  s_waitcnt lgkmcnt(2)
  v_mfma_f32_32x32x16_bf16 v[80:95], v[44:47], a[120:123], v[80:95]
  ds_read_b64_tr_b16 v[36:37], v18 offset:61440
  ds_read_b64_tr_b16 v[38:39], v18 offset:61952
  v_lshlrev_b32 v24, 7, v1
  s_lshl_b32 s77, s90, 11
  s_add_u32 s77, s77, 0
  s_mov_b32 exec_lo, 0xff
  s_mov_b32 exec_hi, 0x0
  buffer_load_dword v23, v24, s[28:31], s77 offen
  s_mov_b64 exec, -1
  v_mfma_f32_32x32x16_bf16 v[96:111], v[28:31], a[120:123], v[96:111]
  s_waitcnt vmcnt(7)
  s_barrier
  ds_read_b64_tr_b16 v[40:41], v13
  ds_read_b64_tr_b16 v[42:43], v13 offset:512
  s_waitcnt lgkmcnt(2)
  v_mfma_f32_32x32x16_bf16 v[80:95], v[32:35], a[124:127], v[80:95]
  ds_read_b64_tr_b16 v[44:45], v13 offset:4096
  ds_read_b64_tr_b16 v[46:47], v13 offset:4608
  s_add_u32 m0, s88, 32768
  s_nop 0
  buffer_load_dwordx4 v9, s[44:47], s58 offen lds
  v_mfma_f32_32x32x16_bf16 v[96:111], v[36:39], a[124:127], v[96:111]
  ds_read_b64_tr_b16 v[28:29], v13 offset:8192
  ds_read_b64_tr_b16 v[30:31], v13 offset:8704
  s_waitcnt lgkmcnt(2)
  v_mfma_f32_32x32x16_bf16 v[48:63], v[40:43], a[0:3], v[64:79]
  ds_read_b64_tr_b16 v[32:33], v13 offset:12288
  ds_read_b64_tr_b16 v[34:35], v13 offset:12800
  v_lshlrev_b32 v24, 7, v1
  s_lshl_b32 s77, s90, 11
  s_add_u32 s77, s77, 1024
  s_mov_b32 exec_lo, 0xff
  s_mov_b32 exec_hi, 0x0
  buffer_load_dword v23, v24, s[28:31], s77 offen
  s_mov_b64 exec, -1
  v_mfma_f32_32x32x16_bf16 v[48:63], v[44:47], a[4:7], v[48:63]
  s_waitcnt vmcnt(3)
  s_barrier
  ds_read_b64_tr_b16 v[36:37], v13 offset:16384
  ds_read_b64_tr_b16 v[38:39], v13 offset:16896
  s_add_u32 m0, s88, 49152
  s_nop 0
  buffer_load_dwordx4 v9, s[44:47], s59 offen lds
  s_waitcnt lgkmcnt(2)
  v_mfma_f32_32x32x16_bf16 v[48:63], v[28:31], a[8:11], v[48:63]
  ds_read_b64_tr_b16 v[40:41], v13 offset:20480
  ds_read_b64_tr_b16 v[42:43], v13 offset:20992
  v_mfma_f32_32x32x16_bf16 v[48:63], v[32:35], a[12:15], v[48:63]
  ds_read_b64_tr_b16 v[44:45], v13 offset:24576
  ds_read_b64_tr_b16 v[46:47], v13 offset:25088
  v_mul_f32 v112, s75, v80
  v_mul_f32 v113, s75, v81
  v_mul_f32 v114, s75, v82
  v_mul_f32 v115, s75, v83
  v_exp_f32 v112, v112
  v_exp_f32 v113, v113
  v_exp_f32 v114, v114
  s_waitcnt lgkmcnt(2)
  v_mfma_f32_32x32x16_bf16 v[48:63], v[36:39], a[16:19], v[48:63]
  ds_read_b64_tr_b16 v[28:29], v13 offset:28672
  ds_read_b64_tr_b16 v[30:31], v13 offset:29184
  v_exp_f32 v115, v115
  v_mul_f32 v88, v80, v88
  v_mul_f32 v89, v81, v89
  v_mul_f32 v90, v82, v90
  v_mul_f32 v91, v83, v91
  v_add_f32 v112, 1.0, v112
  v_mfma_f32_32x32x16_bf16 v[48:63], v[40:43], a[20:23], v[48:63]
  s_waitcnt vmcnt(2)
  s_barrier
  ds_read_b64_tr_b16 v[32:33], v13 offset:32768
  ds_read_b64_tr_b16 v[34:35], v13 offset:33280
  s_add_u32 m0, s88, 0
  s_nop 0
  buffer_load_dwordx4 v9, s[44:47], s60 offen lds
  v_add_f32 v113, 1.0, v113
  v_add_f32 v114, 1.0, v114
  v_add_f32 v115, 1.0, v115
  v_rcp_f32 v112, v112
  v_rcp_f32 v113, v113
  v_rcp_f32 v114, v114
  s_waitcnt lgkmcnt(2)
  v_mfma_f32_32x32x16_bf16 v[48:63], v[44:47], a[24:27], v[48:63]
  ds_read_b64_tr_b16 v[36:37], v13 offset:36864
  ds_read_b64_tr_b16 v[38:39], v13 offset:37376
  s_add_u32 m0, s89, 98304
  s_add_u32 s85, s68, s92
  buffer_load_dwordx4 v3, s[24:27], s85 offen lds
  v_rcp_f32 v115, v115
  v_mul_f32 v88, v112, v88
  v_mul_f32 v89, v113, v89
  v_mul_f32 v90, v114, v90
  v_mul_f32 v91, v115, v91
  v_mul_f32 v116, s75, v84
  v_mfma_f32_32x32x16_bf16 v[48:63], v[28:31], a[28:31], v[48:63]
  ds_read_b64_tr_b16 v[40:41], v13 offset:40960
  ds_read_b64_tr_b16 v[42:43], v13 offset:41472
  s_add_u32 m0, s89, 100352
  s_add_u32 s85, s69, s92
  buffer_load_dwordx4 v3, s[24:27], s85 offen lds
  v_mul_f32 v117, s75, v85
  v_mul_f32 v118, s75, v86
  v_mul_f32 v119, s75, v87
  v_exp_f32 v116, v116
  v_exp_f32 v117, v117
  v_exp_f32 v118, v118
  v_exp_f32 v119, v119
  s_waitcnt lgkmcnt(2)
  v_mfma_f32_32x32x16_bf16 v[48:63], v[32:35], a[32:35], v[48:63]
  ds_read_b64_tr_b16 v[44:45], v13 offset:45056
  ds_read_b64_tr_b16 v[46:47], v13 offset:45568
  s_add_u32 m0, s89, 102400
  s_add_u32 s85, s70, s92
  buffer_load_dwordx4 v3, s[24:27], s85 offen lds
  v_mul_f32 v92, v84, v92
  v_mul_f32 v93, v85, v93
  v_mul_f32 v94, v86, v94
  v_mul_f32 v95, v87, v95
  v_add_f32 v116, 1.0, v116
  v_add_f32 v117, 1.0, v117
  v_mfma_f32_32x32x16_bf16 v[48:63], v[36:39], a[36:39], v[48:63]
  s_waitcnt vmcnt(4)
  s_barrier
  ds_read_b64_tr_b16 v[28:29], v13 offset:49152
  ds_read_b64_tr_b16 v[30:31], v13 offset:49664
  s_add_u32 m0, s89, 104448
  s_add_u32 s85, s71, s92
  buffer_load_dwordx4 v3, s[24:27], s85 offen lds
  v_add_f32 v118, 1.0, v118
  v_add_f32 v119, 1.0, v119
  v_rcp_f32 v116, v116
  v_rcp_f32 v117, v117
  v_rcp_f32 v118, v118
  v_rcp_f32 v119, v119
  s_waitcnt lgkmcnt(2)
  v_mfma_f32_32x32x16_bf16 v[48:63], v[40:43], a[40:43], v[48:63]
  ds_read_b64_tr_b16 v[32:33], v13 offset:53248
  ds_read_b64_tr_b16 v[34:35], v13 offset:53760
  s_add_u32 m0, s88, 16384
  s_nop 0
  buffer_load_dwordx4 v9, s[44:47], s61 offen lds
  v_mul_f32 v92, v116, v92
  v_mul_f32 v93, v117, v93
  v_mul_f32 v94, v118, v94
  v_mul_f32 v95, v119, v95
  v_cvt_pk_bf16_f32 v80, v88, v89
  v_cvt_pk_bf16_f32 v81, v90, v91
  v_mfma_f32_32x32x16_bf16 v[48:63], v[44:47], a[44:47], v[48:63]
  ds_read_b64_tr_b16 v[36:37], v13 offset:57344
  ds_read_b64_tr_b16 v[38:39], v13 offset:57856
  v_cvt_pk_bf16_f32 v82, v92, v93
  v_cvt_pk_bf16_f32 v83, v94, v95
  s_add_u32 s77, s84, s97
  buffer_store_dwordx4 v[80:83], v2, s[32:35], s77 offen sc1
  v_mul_f32 v112, s75, v96
  v_mul_f32 v113, s75, v97
  v_mul_f32 v114, s75, v98
  v_mul_f32 v115, s75, v99
  s_waitcnt lgkmcnt(2)
  v_mfma_f32_32x32x16_bf16 v[48:63], v[28:31], a[48:51], v[48:63]
  ds_read_b64_tr_b16 v[40:41], v13 offset:61440
  ds_read_b64_tr_b16 v[42:43], v13 offset:61952
  v_exp_f32 v112, v112
  v_exp_f32 v113, v113
  v_exp_f32 v114, v114
  v_exp_f32 v115, v115
  v_mul_f32 v104, v96, v104
  v_mul_f32 v105, v97, v105
  v_and_b32 v12, 15, v1
  v_lshlrev_b32 v12, 11, v12
  s_lshl_b32 s77, s5, 7
  s_add_u32 s77, s77, 11599872
  v_add_u32 v12, s77, v12
  buffer_load_dwordx2 v[120:121], v12, s[32:35], 0 offen sc1
  v_mfma_f32_32x32x16_bf16 v[48:63], v[32:35], a[52:55], v[48:63]
  s_waitcnt vmcnt(7)
  s_barrier
  ds_read_b64_tr_b16 v[44:45], v13
  ds_read_b64_tr_b16 v[46:47], v13 offset:512
  s_add_u32 m0, s88, 32768
  s_nop 0
  buffer_load_dwordx4 v9, s[44:47], s62 offen lds
  v_mul_f32 v106, v98, v106
  v_mul_f32 v107, v99, v107
  v_add_f32 v112, 1.0, v112
  v_add_f32 v113, 1.0, v113
  v_add_f32 v114, 1.0, v114
  v_add_f32 v115, 1.0, v115
  s_waitcnt lgkmcnt(2)
  v_mfma_f32_32x32x16_bf16 v[48:63], v[36:39], a[56:59], v[48:63]
  ds_read_b64_tr_b16 v[28:29], v13 offset:4096
  ds_read_b64_tr_b16 v[30:31], v13 offset:4608
  v_rcp_f32 v112, v112
  v_rcp_f32 v113, v113
  v_rcp_f32 v114, v114
  v_rcp_f32 v115, v115
  v_mul_f32 v104, v112, v104
  v_mul_f32 v105, v113, v105
  v_mfma_f32_32x32x16_bf16 v[48:63], v[40:43], a[60:63], v[48:63]
  ds_read_b64_tr_b16 v[32:33], v13 offset:8192
  ds_read_b64_tr_b16 v[34:35], v13 offset:8704
  v_mul_f32 v106, v114, v106
  v_mul_f32 v107, v115, v107
  v_mul_f32 v116, s75, v100
  v_mul_f32 v117, s75, v101
  v_mul_f32 v118, s75, v102
  v_mul_f32 v119, s75, v103
  v_exp_f32 v116, v116
  s_waitcnt lgkmcnt(2)
  v_mfma_f32_32x32x16_bf16 v[48:63], v[44:47], a[64:67], v[48:63]
  ds_read_b64_tr_b16 v[36:37], v13 offset:12288
  ds_read_b64_tr_b16 v[38:39], v13 offset:12800
  v_exp_f32 v117, v117
  v_exp_f32 v118, v118
  v_exp_f32 v119, v119
  v_mul_f32 v108, v100, v108
  v_mul_f32 v109, v101, v109
  v_mul_f32 v110, v102, v110
  s_waitcnt vmcnt(1)
  v_cmp_ne_u64 vcc, s[82:83], v[120:121]
  s_mov_b32 s87, 0
  s_cmp_eq_u64 vcc, 0
  s_cbranch_scc1 LC_kvpoll_done
LC_kvpoll:
  s_sleep 1
  buffer_load_dwordx2 v[120:121], v12, s[32:35], 0 offen offset:0 sc1
  s_waitcnt vmcnt(0)
  v_cmp_ne_u64 vcc, s[82:83], v[120:121]
  s_add_u32 s87, s87, 1
  s_cmp_ge_u32 s87, 262144
  s_cbranch_scc1 LC_kvpoll_done
  s_cmp_eq_u64 vcc, 0
  s_cbranch_scc0 LC_kvpoll
LC_kvpoll_done:
  s_nop 0
  buffer_load_dword v124, v11, s[32:35], 0 offen sc1
  buffer_load_dword v125, v11, s[32:35], 0 offen offset:256 sc1
  buffer_load_dword v126, v11, s[32:35], 0 offen offset:512 sc1
  buffer_load_dword v127, v11, s[32:35], 0 offen offset:768 sc1
  s_lshr_b32 s77, s6, 1
  s_lshl_b32 s77, s77, 11
  s_lshl_b32 s78, s72, 9
  s_add_u32 s77, s77, s78
  s_add_u32 s77, s77, 11599872
  v_and_b32 v17, 3, v1
  v_lshlrev_b32 v17, 7, v17
  v_add_u32 v17, s77, v17
  v_mfma_f32_32x32x16_bf16 v[48:63], v[28:31], a[68:71], v[48:63]
  s_barrier
  ds_read_b64_tr_b16 v[40:41], v13 offset:16384
  ds_read_b64_tr_b16 v[42:43], v13 offset:16896
  s_add_u32 m0, s88, 49152
  s_nop 0
  buffer_load_dwordx4 v9, s[44:47], s63 offen lds
  v_mul_f32 v111, v103, v111
  v_add_f32 v116, 1.0, v116
  v_add_f32 v117, 1.0, v117
  v_add_f32 v118, 1.0, v118
  v_add_f32 v119, 1.0, v119
  v_rcp_f32 v116, v116
  s_waitcnt lgkmcnt(2)
  v_mfma_f32_32x32x16_bf16 v[48:63], v[32:35], a[72:75], v[48:63]
  ds_read_b64_tr_b16 v[44:45], v13 offset:20480
  ds_read_b64_tr_b16 v[46:47], v13 offset:20992
  v_rcp_f32 v117, v117
  v_rcp_f32 v118, v118
  v_rcp_f32 v119, v119
  v_mul_f32 v108, v116, v108
  v_mul_f32 v109, v117, v109
  v_mul_f32 v110, v118, v110
  v_mfma_f32_32x32x16_bf16 v[48:63], v[36:39], a[76:79], v[48:63]
  ds_read_b64_tr_b16 v[28:29], v13 offset:24576
  ds_read_b64_tr_b16 v[30:31], v13 offset:25088
  v_mul_f32 v111, v119, v111
  v_cvt_pk_bf16_f32 v96, v104, v105
  v_cvt_pk_bf16_f32 v97, v106, v107
  v_cvt_pk_bf16_f32 v98, v108, v109
  v_cvt_pk_bf16_f32 v99, v110, v111
  s_add_u32 s77, s84, s97
  buffer_store_dwordx4 v[96:99], v2, s[32:35], s77 offen offset:1024 sc1
  s_waitcnt lgkmcnt(2)
  v_mfma_f32_32x32x16_bf16 v[48:63], v[40:43], a[80:83], v[48:63]
  ds_read_b64_tr_b16 v[32:33], v13 offset:28672
  ds_read_b64_tr_b16 v[34:35], v13 offset:29184
  v_mfma_f32_32x32x16_bf16 v[48:63], v[44:47], a[84:87], v[48:63]
  s_waitcnt vmcnt(6)
  s_barrier
  ds_read_b64_tr_b16 v[36:37], v13 offset:32768
  ds_read_b64_tr_b16 v[38:39], v13 offset:33280
  s_waitcnt lgkmcnt(2)
  v_mfma_f32_32x32x16_bf16 v[48:63], v[28:31], a[88:91], v[48:63]
  ds_read_b64_tr_b16 v[40:41], v13 offset:36864
  ds_read_b64_tr_b16 v[42:43], v13 offset:37376
  v_mfma_f32_32x32x16_bf16 v[48:63], v[32:35], a[92:95], v[48:63]
  ds_read_b64_tr_b16 v[44:45], v13 offset:40960
  ds_read_b64_tr_b16 v[46:47], v13 offset:41472
  s_waitcnt lgkmcnt(2)
  v_mfma_f32_32x32x16_bf16 v[48:63], v[36:39], a[96:99], v[48:63]
  ds_read_b64_tr_b16 v[28:29], v13 offset:45056
  ds_read_b64_tr_b16 v[30:31], v13 offset:45568
  v_mfma_f32_32x32x16_bf16 v[48:63], v[40:43], a[100:103], v[48:63]
  s_waitcnt vmcnt(0)
  s_barrier
  s_cmp_lg_u32 s3, 0
  s_cbranch_scc1 LC_flag1
  v_mov_b32 v24, 0
  v_mov_b32 v26, s82
  v_mov_b32 v27, s83
  s_mov_b64 exec, 1
  buffer_store_dwordx2 v[26:27], v24, s[32:35], s2 offen offset:8 sc1
  s_mov_b64 exec, -1
LC_flag1:
  s_nop 0
  ds_read_b64_tr_b16 v[32:33], v13 offset:49152
  ds_read_b64_tr_b16 v[34:35], v13 offset:49664
  s_waitcnt lgkmcnt(2)
  v_mfma_f32_32x32x16_bf16 v[48:63], v[44:47], a[104:107], v[48:63]
  ds_read_b64_tr_b16 v[36:37], v13 offset:53248
  ds_read_b64_tr_b16 v[38:39], v13 offset:53760
  v_mfma_f32_32x32x16_bf16 v[48:63], v[28:31], a[108:111], v[48:63]
  ds_read_b64_tr_b16 v[40:41], v13 offset:57344
  ds_read_b64_tr_b16 v[42:43], v13 offset:57856
  s_waitcnt lgkmcnt(2)
  v_mfma_f32_32x32x16_bf16 v[48:63], v[32:35], a[112:115], v[48:63]
  ds_read_b64_tr_b16 v[44:45], v13 offset:61440
  ds_read_b64_tr_b16 v[46:47], v13 offset:61952
  v_mfma_f32_32x32x16_bf16 v[48:63], v[36:39], a[116:119], v[48:63]
  s_waitcnt lgkmcnt(0)
  v_mfma_f32_32x32x16_bf16 v[48:63], v[40:43], a[120:123], v[48:63]
  buffer_load_dwordx2 v[10:11], v17, s[32:35], 0 offen offset:8 sc1
  v_mfma_f32_32x32x16_bf16 v[48:63], v[44:47], a[124:127], v[48:63]
  s_lshl_b32 s77, s3, 12
  s_add_u32 s77, s77, 65536
  v_add_u32 v22, s77, v2
  ds_write_b128 v22, v[124:127]
  s_lshr_b32 s48, s64, 4
  s_lshr_b32 s49, s65, 4
  s_lshr_b32 s50, s66, 4
  s_lshr_b32 s51, s67, 4
  s_lshr_b32 s52, s68, 4
  s_lshr_b32 s53, s69, 4
  s_lshr_b32 s54, s70, 4
  s_lshr_b32 s55, s71, 4
  s_waitcnt lgkmcnt(0)
  s_barrier
  s_lshl_b32 s77, s73, 14
  s_add_u32 s77, s77, 65536
  v_add_u32 v22, s77, v2
  ds_read_b128 v[64:67], v22
  ds_read_b128 v[68:71], v22 offset:4096
  ds_read_b128 v[72:75], v22 offset:8192
  ds_read_b128 v[76:79], v22 offset:12288
  v_mul_f32 v112, s74, v48
  v_mul_f32 v113, s74, v49
  v_mul_f32 v114, s74, v50
  v_mul_f32 v115, s74, v51
  v_exp_f32_e64 v112, v112 clamp
  v_exp_f32_e64 v113, v113 clamp
  v_exp_f32_e64 v114, v114 clamp
  v_exp_f32_e64 v115, v115 clamp
  v_max_f32 v48, s76, v48
  v_max_f32 v49, s76, v49
  v_max_f32 v50, s76, v50
  v_max_f32 v51, s76, v51
  v_add_f32 v48, v112, v48
  v_add_f32 v49, v113, v49
  v_add_f32 v50, v114, v50
  v_add_f32 v51, v115, v51
  v_mul_f32 v116, s74, v52
  v_mul_f32 v117, s74, v53
  v_mul_f32 v118, s74, v54
  v_mul_f32 v119, s74, v55
  v_exp_f32_e64 v116, v116 clamp
  v_exp_f32_e64 v117, v117 clamp
  v_exp_f32_e64 v118, v118 clamp
  v_exp_f32_e64 v119, v119 clamp
  v_max_f32 v52, s76, v52
  v_max_f32 v53, s76, v53
  v_max_f32 v54, s76, v54
  v_max_f32 v55, s76, v55
  v_add_f32 v52, v116, v52
  v_add_f32 v53, v117, v53
  v_add_f32 v54, v118, v54
  v_add_f32 v55, v119, v55
  v_mul_f32 v112, s74, v56
  v_mul_f32 v113, s74, v57
  v_mul_f32 v114, s74, v58
  v_mul_f32 v115, s74, v59
  v_exp_f32_e64 v112, v112 clamp
  v_exp_f32_e64 v113, v113 clamp
  v_exp_f32_e64 v114, v114 clamp
  v_exp_f32_e64 v115, v115 clamp
  v_max_f32 v56, s76, v56
  v_max_f32 v57, s76, v57
  v_max_f32 v58, s76, v58
  v_max_f32 v59, s76, v59
  v_add_f32 v56, v112, v56
  v_add_f32 v57, v113, v57
  v_add_f32 v58, v114, v58
  v_add_f32 v59, v115, v59
  v_mul_f32 v116, s74, v60
  v_mul_f32 v117, s74, v61
  v_mul_f32 v118, s74, v62
  v_mul_f32 v119, s74, v63
  v_exp_f32_e64 v116, v116 clamp
  v_exp_f32_e64 v117, v117 clamp
  v_exp_f32_e64 v118, v118 clamp
  v_exp_f32_e64 v119, v119 clamp
  v_max_f32 v60, s76, v60
  v_max_f32 v61, s76, v61
  v_max_f32 v62, s76, v62
  v_max_f32 v63, s76, v63
  v_add_f32 v60, v116, v60
  v_add_f32 v61, v117, v61
  v_add_f32 v62, v118, v62
  v_add_f32 v63, v119, v63
  v_cvt_pk_bf16_f32 v48, v48, v49
  v_cvt_pk_bf16_f32 v49, v50, v51
  v_cvt_pk_bf16_f32 v50, v52, v53
  v_cvt_pk_bf16_f32 v51, v54, v55
  v_cvt_pk_bf16_f32 v52, v56, v57
  v_cvt_pk_bf16_f32 v53, v58, v59
  v_cvt_pk_bf16_f32 v54, v60, v61
  v_cvt_pk_bf16_f32 v55, v62, v63
  s_waitcnt lgkmcnt(1)
  v_cndmask_b32 v112, v64, v72, s[80:81]
  v_cndmask_b32 v120, v72, v64, s[80:81]
  v_cndmask_b32 v113, v65, v73, s[80:81]
  v_cndmask_b32 v121, v73, v65, s[80:81]
  v_cndmask_b32 v114, v66, v74, s[80:81]
  v_cndmask_b32 v122, v74, v66, s[80:81]
  v_cndmask_b32 v115, v67, v75, s[80:81]
  v_cndmask_b32 v123, v75, v67, s[80:81]
  s_waitcnt lgkmcnt(0)
  v_cndmask_b32 v116, v68, v76, s[80:81]
  v_cndmask_b32 v124, v76, v68, s[80:81]
  v_cndmask_b32 v117, v69, v77, s[80:81]
  v_cndmask_b32 v125, v77, v69, s[80:81]
  v_cndmask_b32 v118, v70, v78, s[80:81]
  v_cndmask_b32 v126, v78, v70, s[80:81]
  v_cndmask_b32 v119, v71, v79, s[80:81]
  v_cndmask_b32 v127, v79, v71, s[80:81]
  v_cvt_pk_bf16_f32 v56, v112, v113
  v_cvt_pk_bf16_f32 v57, v114, v115
  v_cvt_pk_bf16_f32 v58, v116, v117
  v_cvt_pk_bf16_f32 v59, v118, v119
  v_cvt_pk_bf16_f32 v60, v120, v121
  v_cvt_pk_bf16_f32 v61, v122, v123
  v_cvt_pk_bf16_f32 v62, v124, v125
  v_cvt_pk_bf16_f32 v63, v126, v127
  v_mfma_f32_32x32x16_bf16 v[64:79], v[56:59], v[48:51], 0
  s_nop 0
  v_mfma_f32_32x32x16_bf16 v[112:127], v[60:63], v[52:55], 0
  s_nop 9
  v_add_f32 v72, s76, v72
  v_rcp_f32 v72, v72
  v_add_f32 v112, s76, v112
  v_rcp_f32 v112, v112
  v_mul_f32 v64, v72, v64
  v_mul_f32 v65, v72, v65
  v_mul_f32 v66, v72, v66
  v_mul_f32 v67, v72, v67
  v_mul_f32 v68, v72, v68
  v_mul_f32 v69, v72, v69
  v_mul_f32 v70, v72, v70
  v_mul_f32 v71, v72, v71
  v_cvt_pk_bf16_f32 v76, v64, v65
  v_cvt_pk_bf16_f32 v77, v66, v67
  v_cvt_pk_bf16_f32 v78, v68, v69
  v_cvt_pk_bf16_f32 v79, v70, v71
  s_add_u32 s77, s84, s97
  s_add_u32 s77, s77, 28672
  buffer_store_dwordx4 v[76:79], v2, s[32:35], s77 offen sc1
  v_mul_f32 v120, v112, v120
  v_mul_f32 v121, v112, v121
  v_mul_f32 v122, v112, v122
  v_mul_f32 v123, v112, v123
  v_mul_f32 v124, v112, v124
  v_mul_f32 v125, v112, v125
  v_mul_f32 v126, v112, v126
  v_mul_f32 v127, v112, v127
  v_cvt_pk_bf16_f32 v116, v120, v121
  v_cvt_pk_bf16_f32 v117, v122, v123
  v_cvt_pk_bf16_f32 v118, v124, v125
  v_cvt_pk_bf16_f32 v119, v126, v127
  s_add_u32 s77, s84, s97
  s_add_u32 s77, s77, 28672
  buffer_store_dwordx4 v[116:119], v2, s[32:35], s77 offen offset:1024 sc1
  s_waitcnt vmcnt(2)
  v_cmp_ne_u64 vcc, s[82:83], v[10:11]
  s_mov_b32 s87, 0
  s_cmp_eq_u64 vcc, 0
  s_cbranch_scc1 LC_poll1_done
LC_poll1:
  s_sleep 1
  buffer_load_dwordx2 v[10:11], v17, s[32:35], 0 offen offset:8 sc1
  s_waitcnt vmcnt(0)
  v_cmp_ne_u64 vcc, s[82:83], v[10:11]
  s_add_u32 s87, s87, 1
  s_cmp_ge_u32 s87, 262144
  s_cbranch_scc1 LC_poll1_done
  s_cmp_eq_u64 vcc, 0
  s_cbranch_scc0 LC_poll1
LC_poll1_done:
  s_nop 0
  s_add_u32 s77, s48, s86
  buffer_load_dwordx4 a[0:3], v2, s[32:35], s77 offen sc1
  s_add_u32 s77, s49, s86
  buffer_load_dwordx4 a[4:7], v2, s[32:35], s77 offen sc1
  s_add_u32 s77, s50, s86
  buffer_load_dwordx4 a[8:11], v2, s[32:35], s77 offen sc1
  s_add_u32 s77, s51, s86
  buffer_load_dwordx4 a[12:15], v2, s[32:35], s77 offen sc1
  s_add_u32 s77, s52, s86
  buffer_load_dwordx4 a[16:19], v2, s[32:35], s77 offen sc1
  s_add_u32 s77, s53, s86
  buffer_load_dwordx4 a[20:23], v2, s[32:35], s77 offen sc1
  s_add_u32 m0, s89, 0
  s_add_u32 s85, s64, s92
  s_add_u32 s85, s85, 131072
  buffer_load_dwordx4 v3, s[24:27], s85 offen lds
  s_add_u32 m0, s89, 2048
  s_add_u32 s85, s65, s92
  s_add_u32 s85, s85, 131072
  buffer_load_dwordx4 v3, s[24:27], s85 offen lds
  s_waitcnt vmcnt(8)
  s_waitcnt lgkmcnt(0)
  s_barrier
  s_cmp_lg_u32 s3, 0
  s_cbranch_scc1 LC_flag2
  v_mov_b32 v24, 0
  v_mov_b32 v26, s82
  v_mov_b32 v27, s83
  s_mov_b64 exec, 1
  buffer_store_dwordx2 v[26:27], v24, s[32:35], s2 offen offset:16 sc1
  s_mov_b64 exec, -1
LC_flag2:
  s_nop 0
  v_and_b32 v24, 31, v1
  v_lshlrev_b32 v24, 2, v24
  s_lshl_b32 s77, s6, 8
  s_lshl_b32 s78, s73, 7
  s_add_u32 s77, s77, s78
  s_add_u32 s77, s77, 11534336
  buffer_load_dword v112, v24, s[32:35], s77 offen sc1
  ds_read_b64_tr_b16 v[28:29], v4
  ds_read_b64_tr_b16 v[30:31], v4 offset:512
  ds_read_b64_tr_b16 v[32:33], v21
  ds_read_b64_tr_b16 v[34:35], v21 offset:512
  ds_read_b64_tr_b16 v[36:37], v4 offset:2048
  ds_read_b64_tr_b16 v[38:39], v4 offset:2560
  ds_read_b64_tr_b16 v[40:41], v21 offset:2048
  ds_read_b64_tr_b16 v[42:43], v21 offset:2560
  s_waitcnt lgkmcnt(6) vmcnt(8)
  v_mfma_f32_32x32x16_bf16 v[80:95], v[28:31], a[0:3], 0
  ds_read_b64_tr_b16 v[120:121], v4 offset:4096
  ds_read_b64_tr_b16 v[122:123], v4 offset:4608
  ds_read_b64_tr_b16 v[124:125], v21 offset:4096
  ds_read_b64_tr_b16 v[126:127], v21 offset:4608
  s_add_u32 m0, s89, 4096
  s_add_u32 s85, s66, s92
  s_add_u32 s85, s85, 131072
  buffer_load_dwordx4 v3, s[24:27], s85 offen lds
  s_add_u32 m0, s89, 6144
  s_add_u32 s85, s67, s92
  s_add_u32 s85, s85, 131072
  buffer_load_dwordx4 v3, s[24:27], s85 offen lds
  s_waitcnt lgkmcnt(8)
  v_mfma_f32_32x32x16_bf16 v[96:111], v[32:35], a[0:3], 0
  s_add_u32 m0, s89, 32768
  s_add_u32 s85, s68, s92
  s_add_u32 s85, s85, 131072
  buffer_load_dwordx4 v3, s[24:27], s85 offen lds
  s_add_u32 m0, s89, 34816
  s_add_u32 s85, s69, s92
  s_add_u32 s85, s85, 131072
  buffer_load_dwordx4 v3, s[24:27], s85 offen lds
  s_waitcnt lgkmcnt(6) vmcnt(11)
  v_mfma_f32_32x32x16_bf16 v[80:95], v[36:39], a[4:7], v[80:95]
  ds_read_b64_tr_b16 v[28:29], v4 offset:6144
  ds_read_b64_tr_b16 v[30:31], v4 offset:6656
  ds_read_b64_tr_b16 v[32:33], v21 offset:6144
  ds_read_b64_tr_b16 v[34:35], v21 offset:6656
  s_add_u32 m0, s89, 36864
  s_add_u32 s85, s70, s92
  s_add_u32 s85, s85, 131072
  buffer_load_dwordx4 v3, s[24:27], s85 offen lds
  s_add_u32 m0, s89, 38912
  s_add_u32 s85, s71, s92
  s_add_u32 s85, s85, 131072
  buffer_load_dwordx4 v3, s[24:27], s85 offen lds
  s_waitcnt lgkmcnt(8)
  v_mfma_f32_32x32x16_bf16 v[96:111], v[40:43], a[4:7], v[96:111]
  s_add_u32 s77, s54, s86
  buffer_load_dwordx4 a[24:27], v2, s[32:35], s77 offen sc1
  s_add_u32 s77, s55, s86
  buffer_load_dwordx4 a[28:31], v2, s[32:35], s77 offen sc1
  s_waitcnt lgkmcnt(6) vmcnt(14)
  v_mfma_f32_32x32x16_bf16 v[80:95], v[120:123], a[8:11], v[80:95]
  s_barrier
  ds_read_b64_tr_b16 v[36:37], v7 offset:32768
  ds_read_b64_tr_b16 v[38:39], v7 offset:33280
  ds_read_b64_tr_b16 v[40:41], v8 offset:32768
  ds_read_b64_tr_b16 v[42:43], v8 offset:33280
  s_add_u32 s77, s48, s86
  s_add_u32 s77, s77, 8192
  buffer_load_dwordx4 a[32:35], v2, s[32:35], s77 offen sc1
  s_add_u32 s77, s49, s86
  s_add_u32 s77, s77, 8192
  buffer_load_dwordx4 a[36:39], v2, s[32:35], s77 offen sc1
  s_waitcnt lgkmcnt(8)
  v_mfma_f32_32x32x16_bf16 v[96:111], v[124:127], a[8:11], v[96:111]
  s_add_u32 s77, s50, s86
  s_add_u32 s77, s77, 8192
  buffer_load_dwordx4 a[40:43], v2, s[32:35], s77 offen sc1
  s_add_u32 s77, s51, s86
  s_add_u32 s77, s77, 8192
  buffer_load_dwordx4 a[44:47], v2, s[32:35], s77 offen sc1
  s_waitcnt lgkmcnt(6) vmcnt(17)
  v_mfma_f32_32x32x16_bf16 v[80:95], v[28:31], a[12:15], v[80:95]
  ds_read_b64_tr_b16 v[120:121], v7 offset:34816
  ds_read_b64_tr_b16 v[122:123], v7 offset:35328
  ds_read_b64_tr_b16 v[124:125], v8 offset:34816
  ds_read_b64_tr_b16 v[126:127], v8 offset:35328
  s_add_u32 s77, s52, s86
  s_add_u32 s77, s77, 8192
  buffer_load_dwordx4 a[48:51], v2, s[32:35], s77 offen sc1
  s_add_u32 s77, s53, s86
  s_add_u32 s77, s77, 8192
  buffer_load_dwordx4 a[52:55], v2, s[32:35], s77 offen sc1
  s_waitcnt lgkmcnt(8)
  v_mfma_f32_32x32x16_bf16 v[96:111], v[32:35], a[12:15], v[96:111]
  s_add_u32 s77, s54, s86
  s_add_u32 s77, s77, 8192
  buffer_load_dwordx4 a[56:59], v2, s[32:35], s77 offen sc1
  s_add_u32 s77, s55, s86
  s_add_u32 s77, s77, 8192
  buffer_load_dwordx4 a[60:63], v2, s[32:35], s77 offen sc1
  s_waitcnt lgkmcnt(6) vmcnt(20)
  v_mfma_f32_32x32x16_bf16 v[80:95], v[36:39], a[16:19], v[80:95]
  ds_read_b64_tr_b16 v[28:29], v7 offset:36864
  ds_read_b64_tr_b16 v[30:31], v7 offset:37376
  ds_read_b64_tr_b16 v[32:33], v8 offset:36864
  ds_read_b64_tr_b16 v[34:35], v8 offset:37376
  s_add_u32 s77, s48, s86
  s_add_u32 s77, s77, 20480
  buffer_load_dwordx4 a[64:67], v2, s[32:35], s77 offen sc1
  s_add_u32 s77, s49, s86
  s_add_u32 s77, s77, 20480
  buffer_load_dwordx4 a[68:71], v2, s[32:35], s77 offen sc1
  s_waitcnt lgkmcnt(8)
  v_mfma_f32_32x32x16_bf16 v[96:111], v[40:43], a[16:19], v[96:111]
  s_add_u32 s77, s50, s86
  s_add_u32 s77, s77, 20480
  buffer_load_dwordx4 a[72:75], v2, s[32:35], s77 offen sc1
  s_add_u32 s77, s51, s86
  s_add_u32 s77, s77, 20480
  buffer_load_dwordx4 a[76:79], v2, s[32:35], s77 offen sc1
  s_waitcnt lgkmcnt(6) vmcnt(23)
  v_mfma_f32_32x32x16_bf16 v[80:95], v[120:123], a[20:23], v[80:95]
  ds_read_b64_tr_b16 v[36:37], v7 offset:38912
  ds_read_b64_tr_b16 v[38:39], v7 offset:39424
  ds_read_b64_tr_b16 v[40:41], v8 offset:38912
  ds_read_b64_tr_b16 v[42:43], v8 offset:39424
  s_add_u32 s77, s52, s86
  s_add_u32 s77, s77, 20480
  buffer_load_dwordx4 a[80:83], v2, s[32:35], s77 offen sc1
  s_add_u32 s77, s53, s86
  s_add_u32 s77, s77, 20480
  buffer_load_dwordx4 a[84:87], v2, s[32:35], s77 offen sc1
  s_waitcnt lgkmcnt(8)
  v_mfma_f32_32x32x16_bf16 v[96:111], v[124:127], a[20:23], v[96:111]
  s_add_u32 s77, s54, s86
  s_add_u32 s77, s77, 20480
  buffer_load_dwordx4 a[88:91], v2, s[32:35], s77 offen sc1
  s_add_u32 s77, s55, s86
  s_add_u32 s77, s77, 20480
  buffer_load_dwordx4 a[92:95], v2, s[32:35], s77 offen sc1
  s_waitcnt lgkmcnt(6) vmcnt(17)
  v_mfma_f32_32x32x16_bf16 v[80:95], v[28:31], a[24:27], v[80:95]
  s_barrier
  ds_read_b64_tr_b16 v[120:121], v5
  ds_read_b64_tr_b16 v[122:123], v5 offset:512
  ds_read_b64_tr_b16 v[124:125], v6
  ds_read_b64_tr_b16 v[126:127], v6 offset:512
  s_add_u32 m0, s89, 65536
  s_add_u32 s85, s64, s92
  s_add_u32 s85, s85, 327680
  buffer_load_dwordx4 v3, s[24:27], s85 offen lds
  s_add_u32 m0, s89, 67584
  s_add_u32 s85, s65, s92
  s_add_u32 s85, s85, 327680
  buffer_load_dwordx4 v3, s[24:27], s85 offen lds
  s_waitcnt lgkmcnt(8)
  v_mfma_f32_32x32x16_bf16 v[96:111], v[32:35], a[24:27], v[96:111]
  s_add_u32 m0, s89, 69632
  s_add_u32 s85, s66, s92
  s_add_u32 s85, s85, 327680
  buffer_load_dwordx4 v3, s[24:27], s85 offen lds
  s_add_u32 m0, s89, 71680
  s_add_u32 s85, s67, s92
  s_add_u32 s85, s85, 327680
  buffer_load_dwordx4 v3, s[24:27], s85 offen lds
  s_waitcnt lgkmcnt(6) vmcnt(20)
  v_mfma_f32_32x32x16_bf16 v[80:95], v[36:39], a[28:31], v[80:95]
  ds_read_b64_tr_b16 v[28:29], v5 offset:2048
  ds_read_b64_tr_b16 v[30:31], v5 offset:2560
  ds_read_b64_tr_b16 v[32:33], v6 offset:2048
  ds_read_b64_tr_b16 v[34:35], v6 offset:2560
  s_add_u32 m0, s89, 131072
  s_add_u32 s85, s68, s92
  s_add_u32 s85, s85, 327680
  buffer_load_dwordx4 v3, s[24:27], s85 offen lds
  s_add_u32 m0, s89, 133120
  s_add_u32 s85, s69, s92
  s_add_u32 s85, s85, 327680
  buffer_load_dwordx4 v3, s[24:27], s85 offen lds
  s_waitcnt lgkmcnt(8)
  v_mfma_f32_32x32x16_bf16 v[96:111], v[40:43], a[28:31], v[96:111]
  s_add_u32 m0, s89, 135168
  s_add_u32 s85, s70, s92
  s_add_u32 s85, s85, 327680
  buffer_load_dwordx4 v3, s[24:27], s85 offen lds
  s_add_u32 m0, s89, 137216
  s_add_u32 s85, s71, s92
  s_add_u32 s85, s85, 327680
  buffer_load_dwordx4 v3, s[24:27], s85 offen lds
  s_waitcnt lgkmcnt(6) vmcnt(23)
  v_mfma_f32_32x32x16_bf16 v[80:95], v[120:123], a[32:35], v[80:95]
  ds_read_b64_tr_b16 v[36:37], v5 offset:4096
  ds_read_b64_tr_b16 v[38:39], v5 offset:4608
  ds_read_b64_tr_b16 v[40:41], v6 offset:4096
  ds_read_b64_tr_b16 v[42:43], v6 offset:4608
  s_waitcnt lgkmcnt(8)
  v_mfma_f32_32x32x16_bf16 v[96:111], v[124:127], a[32:35], v[96:111]
  s_waitcnt lgkmcnt(6) vmcnt(22)
  v_mfma_f32_32x32x16_bf16 v[80:95], v[28:31], a[36:39], v[80:95]
  ds_read_b64_tr_b16 v[120:121], v5 offset:6144
  ds_read_b64_tr_b16 v[122:123], v5 offset:6656
  ds_read_b64_tr_b16 v[124:125], v6 offset:6144
  ds_read_b64_tr_b16 v[126:127], v6 offset:6656
  s_waitcnt lgkmcnt(8)
  v_mfma_f32_32x32x16_bf16 v[96:111], v[32:35], a[36:39], v[96:111]
  s_waitcnt lgkmcnt(6) vmcnt(21)
  v_mfma_f32_32x32x16_bf16 v[80:95], v[36:39], a[40:43], v[80:95]
  s_barrier
  ds_read_b64_tr_b16 v[28:29], v5 offset:32768
  ds_read_b64_tr_b16 v[30:31], v5 offset:33280
  ds_read_b64_tr_b16 v[32:33], v6 offset:32768
  ds_read_b64_tr_b16 v[34:35], v6 offset:33280
  s_add_u32 m0, s89, 98304
  s_add_u32 s85, s64, s93
  buffer_load_dwordx4 v3, s[28:31], s85 offen lds
  s_add_u32 m0, s89, 100352
  s_add_u32 s85, s65, s93
  buffer_load_dwordx4 v3, s[28:31], s85 offen lds
  s_waitcnt lgkmcnt(8)
  v_mfma_f32_32x32x16_bf16 v[96:111], v[40:43], a[40:43], v[96:111]
  s_add_u32 m0, s89, 102400
  s_add_u32 s85, s66, s93
  buffer_load_dwordx4 v3, s[28:31], s85 offen lds
  s_add_u32 m0, s89, 104448
  s_add_u32 s85, s67, s93
  buffer_load_dwordx4 v3, s[28:31], s85 offen lds
  s_waitcnt lgkmcnt(6) vmcnt(24)
  v_mfma_f32_32x32x16_bf16 v[80:95], v[120:123], a[44:47], v[80:95]
  ds_read_b64_tr_b16 v[36:37], v5 offset:34816
  ds_read_b64_tr_b16 v[38:39], v5 offset:35328
  ds_read_b64_tr_b16 v[40:41], v6 offset:34816
  ds_read_b64_tr_b16 v[42:43], v6 offset:35328
  s_waitcnt lgkmcnt(8)
  v_mfma_f32_32x32x16_bf16 v[96:111], v[124:127], a[44:47], v[96:111]
  s_waitcnt lgkmcnt(6) vmcnt(23)
  v_mfma_f32_32x32x16_bf16 v[80:95], v[28:31], a[48:51], v[80:95]
  ds_read_b64_tr_b16 v[120:121], v5 offset:36864
  ds_read_b64_tr_b16 v[122:123], v5 offset:37376
  ds_read_b64_tr_b16 v[124:125], v6 offset:36864
  ds_read_b64_tr_b16 v[126:127], v6 offset:37376
  s_waitcnt lgkmcnt(8)
  v_mfma_f32_32x32x16_bf16 v[96:111], v[32:35], a[48:51], v[96:111]
  s_waitcnt lgkmcnt(6) vmcnt(22)
  v_mfma_f32_32x32x16_bf16 v[80:95], v[36:39], a[52:55], v[80:95]
  ds_read_b64_tr_b16 v[28:29], v5 offset:38912
  ds_read_b64_tr_b16 v[30:31], v5 offset:39424
  ds_read_b64_tr_b16 v[32:33], v6 offset:38912
  ds_read_b64_tr_b16 v[34:35], v6 offset:39424
  s_waitcnt lgkmcnt(8)
  v_mfma_f32_32x32x16_bf16 v[96:111], v[40:43], a[52:55], v[96:111]
  s_waitcnt lgkmcnt(6) vmcnt(21)
  v_mfma_f32_32x32x16_bf16 v[80:95], v[120:123], a[56:59], v[80:95]
  s_waitcnt vmcnt(8)
  s_barrier
  ds_read_b64_tr_b16 v[36:37], v7
  ds_read_b64_tr_b16 v[38:39], v7 offset:512
  ds_read_b64_tr_b16 v[40:41], v8
  ds_read_b64_tr_b16 v[42:43], v8 offset:512
  s_add_u32 m0, s89, 0
  s_add_u32 s85, s68, s93
  buffer_load_dwordx4 v3, s[28:31], s85 offen lds
  s_add_u32 m0, s89, 2048
  s_add_u32 s85, s69, s93
  buffer_load_dwordx4 v3, s[28:31], s85 offen lds
  s_waitcnt lgkmcnt(8)
  v_mfma_f32_32x32x16_bf16 v[96:111], v[124:127], a[56:59], v[96:111]
  s_add_u32 m0, s89, 4096
  s_add_u32 s85, s70, s93
  buffer_load_dwordx4 v3, s[28:31], s85 offen lds
  s_add_u32 m0, s89, 6144
  s_add_u32 s85, s71, s93
  buffer_load_dwordx4 v3, s[28:31], s85 offen lds
  buffer_load_dwordx2 v[46:47], v17, s[32:35], 0 offen offset:16 sc1
  s_waitcnt lgkmcnt(6)
  v_mfma_f32_32x32x16_bf16 v[80:95], v[28:31], a[60:63], v[80:95]
  ds_read_b64_tr_b16 v[120:121], v7 offset:2048
  ds_read_b64_tr_b16 v[122:123], v7 offset:2560
  ds_read_b64_tr_b16 v[124:125], v8 offset:2048
  ds_read_b64_tr_b16 v[126:127], v8 offset:2560
  s_waitcnt lgkmcnt(8)
  v_mfma_f32_32x32x16_bf16 v[96:111], v[32:35], a[60:63], v[96:111]
  s_waitcnt lgkmcnt(6)
  v_mfma_f32_32x32x16_bf16 v[80:95], v[36:39], a[64:67], v[80:95]
  ds_read_b64_tr_b16 v[28:29], v7 offset:4096
  ds_read_b64_tr_b16 v[30:31], v7 offset:4608
  ds_read_b64_tr_b16 v[32:33], v8 offset:4096
  ds_read_b64_tr_b16 v[34:35], v8 offset:4608
  s_waitcnt lgkmcnt(8)
  v_mfma_f32_32x32x16_bf16 v[96:111], v[40:43], a[64:67], v[96:111]
  s_waitcnt lgkmcnt(6)
  v_mfma_f32_32x32x16_bf16 v[80:95], v[120:123], a[68:71], v[80:95]
  ds_read_b64_tr_b16 v[36:37], v7 offset:6144
  ds_read_b64_tr_b16 v[38:39], v7 offset:6656
  ds_read_b64_tr_b16 v[40:41], v8 offset:6144
  ds_read_b64_tr_b16 v[42:43], v8 offset:6656
  s_waitcnt lgkmcnt(8)
  v_mfma_f32_32x32x16_bf16 v[96:111], v[124:127], a[68:71], v[96:111]
  s_waitcnt lgkmcnt(6)
  v_mfma_f32_32x32x16_bf16 v[80:95], v[28:31], a[72:75], v[80:95]
  s_waitcnt vmcnt(9)
  s_barrier
  ds_read_b64_tr_b16 v[120:121], v4
  ds_read_b64_tr_b16 v[122:123], v4 offset:512
  ds_read_b64_tr_b16 v[124:125], v21
  ds_read_b64_tr_b16 v[126:127], v21 offset:512
  s_add_u32 m0, s89, 32768
  s_and_b32 s85, s64, 49152
  s_add_u32 s85, s85, s92
  s_add_u32 s85, s85, 262144
  buffer_load_dwordx4 v3, s[24:27], s85 offen lds
  s_add_u32 m0, s89, 34816
  s_and_b32 s85, s65, 49152
  s_add_u32 s85, s85, s92
  s_add_u32 s85, s85, 262144
  buffer_load_dwordx4 v3, s[24:27], s85 offen lds
  s_waitcnt lgkmcnt(8)
  v_mfma_f32_32x32x16_bf16 v[96:111], v[32:35], a[72:75], v[96:111]
  s_add_u32 m0, s89, 36864
  s_and_b32 s85, s66, 49152
  s_add_u32 s85, s85, s92
  s_add_u32 s85, s85, 262144
  buffer_load_dwordx4 v3, s[24:27], s85 offen lds
  s_add_u32 m0, s89, 38912
  s_and_b32 s85, s67, 49152
  s_add_u32 s85, s85, s92
  s_add_u32 s85, s85, 262144
  buffer_load_dwordx4 v3, s[24:27], s85 offen lds
  s_waitcnt lgkmcnt(6)
  v_mfma_f32_32x32x16_bf16 v[80:95], v[36:39], a[76:79], v[80:95]
  ds_read_b64_tr_b16 v[28:29], v4 offset:2048
  ds_read_b64_tr_b16 v[30:31], v4 offset:2560
  ds_read_b64_tr_b16 v[32:33], v21 offset:2048
  ds_read_b64_tr_b16 v[34:35], v21 offset:2560
  s_waitcnt vmcnt(4)
  v_cmp_ne_u64 vcc, s[82:83], v[46:47]
  s_mov_b32 s87, 0
  s_cmp_eq_u64 vcc, 0
  s_cbranch_scc1 LC_poll2_done
LC_poll2:
  s_sleep 1
  buffer_load_dwordx2 v[46:47], v17, s[32:35], 0 offen offset:16 sc1
  s_waitcnt vmcnt(0)
  v_cmp_ne_u64 vcc, s[82:83], v[46:47]
  s_add_u32 s87, s87, 1
  s_cmp_ge_u32 s87, 262144
  s_cbranch_scc1 LC_poll2_done
  s_cmp_eq_u64 vcc, 0
  s_cbranch_scc0 LC_poll2
LC_poll2_done:
  s_nop 0
  s_add_u32 s77, s48, s86
  s_add_u32 s77, s77, 28672
  buffer_load_dwordx4 a[96:99], v2, s[32:35], s77 offen sc1
  s_waitcnt lgkmcnt(8)
  v_mfma_f32_32x32x16_bf16 v[96:111], v[40:43], a[76:79], v[96:111]
  s_add_u32 s77, s49, s86
  s_add_u32 s77, s77, 28672
  buffer_load_dwordx4 a[100:103], v2, s[32:35], s77 offen sc1
  s_add_u32 s77, s50, s86
  s_add_u32 s77, s77, 28672
  buffer_load_dwordx4 a[104:107], v2, s[32:35], s77 offen sc1
  s_waitcnt lgkmcnt(6)
  v_mfma_f32_32x32x16_bf16 v[80:95], v[120:123], a[80:83], v[80:95]
  ds_read_b64_tr_b16 v[36:37], v4 offset:4096
  ds_read_b64_tr_b16 v[38:39], v4 offset:4608
  ds_read_b64_tr_b16 v[40:41], v21 offset:4096
  ds_read_b64_tr_b16 v[42:43], v21 offset:4608
  s_add_u32 s77, s51, s86
  s_add_u32 s77, s77, 28672
  buffer_load_dwordx4 a[108:111], v2, s[32:35], s77 offen sc1
  s_add_u32 s77, s52, s86
  s_add_u32 s77, s77, 28672
  buffer_load_dwordx4 a[112:115], v2, s[32:35], s77 offen sc1
  s_waitcnt lgkmcnt(8)
  v_mfma_f32_32x32x16_bf16 v[96:111], v[124:127], a[80:83], v[96:111]
  s_add_u32 s77, s53, s86
  s_add_u32 s77, s77, 28672
  buffer_load_dwordx4 a[116:119], v2, s[32:35], s77 offen sc1
  s_add_u32 s77, s54, s86
  s_add_u32 s77, s77, 28672
  buffer_load_dwordx4 a[120:123], v2, s[32:35], s77 offen sc1
  s_waitcnt lgkmcnt(6)
  v_mfma_f32_32x32x16_bf16 v[80:95], v[28:31], a[84:87], v[80:95]
  ds_read_b64_tr_b16 v[120:121], v4 offset:6144
  ds_read_b64_tr_b16 v[122:123], v4 offset:6656
  ds_read_b64_tr_b16 v[124:125], v21 offset:6144
  ds_read_b64_tr_b16 v[126:127], v21 offset:6656
  s_add_u32 s77, s55, s86
  s_add_u32 s77, s77, 28672
  buffer_load_dwordx4 a[124:127], v2, s[32:35], s77 offen sc1
  s_and_b32 s77, s48, 3072
  s_add_u32 s77, s77, s86
  s_add_u32 s77, s77, 16384
  buffer_load_dwordx4 a[0:3], v2, s[32:35], s77 offen sc1
  s_waitcnt lgkmcnt(8)
  v_mfma_f32_32x32x16_bf16 v[96:111], v[32:35], a[84:87], v[96:111]
  s_and_b32 s77, s49, 3072
  s_add_u32 s77, s77, s86
  s_add_u32 s77, s77, 16384
  buffer_load_dwordx4 a[4:7], v2, s[32:35], s77 offen sc1
  s_and_b32 s77, s50, 3072
  s_add_u32 s77, s77, s86
  s_add_u32 s77, s77, 16384
  buffer_load_dwordx4 a[8:11], v2, s[32:35], s77 offen sc1
  s_waitcnt lgkmcnt(6)
  v_mfma_f32_32x32x16_bf16 v[80:95], v[36:39], a[88:91], v[80:95]
  s_barrier
  ds_read_b64_tr_b16 v[28:29], v7 offset:32768
  ds_read_b64_tr_b16 v[30:31], v7 offset:33280
  ds_read_b64_tr_b16 v[32:33], v8 offset:32768
  ds_read_b64_tr_b16 v[34:35], v8 offset:33280
  s_and_b32 s77, s51, 3072
  s_add_u32 s77, s77, s86
  s_add_u32 s77, s77, 16384
  buffer_load_dwordx4 a[12:15], v2, s[32:35], s77 offen sc1
  s_waitcnt lgkmcnt(8)
  v_mfma_f32_32x32x16_bf16 v[96:111], v[40:43], a[88:91], v[96:111]
  s_waitcnt lgkmcnt(6)
  v_mfma_f32_32x32x16_bf16 v[80:95], v[120:123], a[92:95], v[80:95]
  ds_read_b64_tr_b16 v[36:37], v7 offset:34816
  ds_read_b64_tr_b16 v[38:39], v7 offset:35328
  ds_read_b64_tr_b16 v[40:41], v8 offset:34816
  ds_read_b64_tr_b16 v[42:43], v8 offset:35328
  s_waitcnt lgkmcnt(8)
  v_mfma_f32_32x32x16_bf16 v[96:111], v[124:127], a[92:95], v[96:111]
  s_waitcnt lgkmcnt(6) vmcnt(11)
  v_mfma_f32_32x32x16_bf16 v[48:63], v[28:31], a[96:99], 0
  ds_read_b64_tr_b16 v[120:121], v7 offset:36864
  ds_read_b64_tr_b16 v[122:123], v7 offset:37376
  ds_read_b64_tr_b16 v[124:125], v8 offset:36864
  ds_read_b64_tr_b16 v[126:127], v8 offset:37376
  s_waitcnt lgkmcnt(8)
  v_mfma_f32_32x32x16_bf16 v[64:79], v[32:35], a[96:99], 0
  s_waitcnt lgkmcnt(6) vmcnt(10)
  v_mfma_f32_32x32x16_bf16 v[48:63], v[36:39], a[100:103], v[48:63]
  ds_read_b64_tr_b16 v[28:29], v7 offset:38912
  ds_read_b64_tr_b16 v[30:31], v7 offset:39424
  ds_read_b64_tr_b16 v[32:33], v8 offset:38912
  ds_read_b64_tr_b16 v[34:35], v8 offset:39424
  s_waitcnt lgkmcnt(8)
  v_mfma_f32_32x32x16_bf16 v[64:79], v[40:43], a[100:103], v[64:79]
  s_waitcnt lgkmcnt(6) vmcnt(9)
  v_mfma_f32_32x32x16_bf16 v[48:63], v[120:123], a[104:107], v[48:63]
  s_barrier
  ds_read_b64_tr_b16 v[36:37], v5
  ds_read_b64_tr_b16 v[38:39], v5 offset:512
  ds_read_b64_tr_b16 v[40:41], v6
  ds_read_b64_tr_b16 v[42:43], v6 offset:512
  s_waitcnt lgkmcnt(8)
  v_mfma_f32_32x32x16_bf16 v[64:79], v[124:127], a[104:107], v[64:79]
  s_waitcnt lgkmcnt(6) vmcnt(8)
  v_mfma_f32_32x32x16_bf16 v[48:63], v[28:31], a[108:111], v[48:63]
  ds_read_b64_tr_b16 v[120:121], v5 offset:2048
  ds_read_b64_tr_b16 v[122:123], v5 offset:2560
  ds_read_b64_tr_b16 v[124:125], v6 offset:2048
  ds_read_b64_tr_b16 v[126:127], v6 offset:2560
  s_waitcnt lgkmcnt(8)
  v_mfma_f32_32x32x16_bf16 v[64:79], v[32:35], a[108:111], v[64:79]
  s_waitcnt lgkmcnt(6) vmcnt(7)
  v_mfma_f32_32x32x16_bf16 v[48:63], v[36:39], a[112:115], v[48:63]
  ds_read_b64_tr_b16 v[28:29], v5 offset:4096
  ds_read_b64_tr_b16 v[30:31], v5 offset:4608
  ds_read_b64_tr_b16 v[32:33], v6 offset:4096
  ds_read_b64_tr_b16 v[34:35], v6 offset:4608
  s_waitcnt lgkmcnt(8)
  v_mfma_f32_32x32x16_bf16 v[64:79], v[40:43], a[112:115], v[64:79]
  s_waitcnt lgkmcnt(6) vmcnt(6)
  v_mfma_f32_32x32x16_bf16 v[48:63], v[120:123], a[116:119], v[48:63]
  ds_read_b64_tr_b16 v[36:37], v5 offset:6144
  ds_read_b64_tr_b16 v[38:39], v5 offset:6656
  ds_read_b64_tr_b16 v[40:41], v6 offset:6144
  ds_read_b64_tr_b16 v[42:43], v6 offset:6656
  s_waitcnt lgkmcnt(8)
  v_mfma_f32_32x32x16_bf16 v[64:79], v[124:127], a[116:119], v[64:79]
  s_waitcnt lgkmcnt(6) vmcnt(5)
  v_mfma_f32_32x32x16_bf16 v[48:63], v[28:31], a[120:123], v[48:63]
  s_barrier
  ds_read_b64_tr_b16 v[120:121], v5 offset:32768
  ds_read_b64_tr_b16 v[122:123], v5 offset:33280
  ds_read_b64_tr_b16 v[124:125], v6 offset:32768
  ds_read_b64_tr_b16 v[126:127], v6 offset:33280
  s_waitcnt lgkmcnt(8)
  v_mfma_f32_32x32x16_bf16 v[64:79], v[32:35], a[120:123], v[64:79]
  s_waitcnt lgkmcnt(6) vmcnt(4)
  v_mfma_f32_32x32x16_bf16 v[48:63], v[36:39], a[124:127], v[48:63]
  ds_read_b64_tr_b16 v[28:29], v5 offset:34816
  ds_read_b64_tr_b16 v[30:31], v5 offset:35328
  ds_read_b64_tr_b16 v[32:33], v6 offset:34816
  ds_read_b64_tr_b16 v[34:35], v6 offset:35328
  s_waitcnt lgkmcnt(8)
  v_mfma_f32_32x32x16_bf16 v[64:79], v[40:43], a[124:127], v[64:79]
  s_waitcnt lgkmcnt(6) vmcnt(3)
  v_mfma_f32_32x32x16_bf16 v[80:95], v[120:123], a[0:3], v[80:95]
  ds_read_b64_tr_b16 v[36:37], v5 offset:36864
  ds_read_b64_tr_b16 v[38:39], v5 offset:37376
  ds_read_b64_tr_b16 v[40:41], v6 offset:36864
  ds_read_b64_tr_b16 v[42:43], v6 offset:37376
  s_waitcnt lgkmcnt(8)
  v_mfma_f32_32x32x16_bf16 v[96:111], v[124:127], a[0:3], v[96:111]
  s_waitcnt lgkmcnt(6) vmcnt(2)
  v_mfma_f32_32x32x16_bf16 v[80:95], v[28:31], a[4:7], v[80:95]
  ds_read_b64_tr_b16 v[120:121], v5 offset:38912
  ds_read_b64_tr_b16 v[122:123], v5 offset:39424
  ds_read_b64_tr_b16 v[124:125], v6 offset:38912
  ds_read_b64_tr_b16 v[126:127], v6 offset:39424
  s_waitcnt lgkmcnt(8)
  v_mfma_f32_32x32x16_bf16 v[96:111], v[32:35], a[4:7], v[96:111]
  v_sub_f32 v113, 1.0, v112
  v_mul_f32 v48, v112, v48
  v_mul_f32 v49, v112, v49
  v_mul_f32 v50, v112, v50
  v_mul_f32 v51, v112, v51
  v_mul_f32 v52, v112, v52
  v_mul_f32 v53, v112, v53
  v_mul_f32 v54, v112, v54
  v_mul_f32 v55, v112, v55
  v_mul_f32 v56, v112, v56
  v_mul_f32 v57, v112, v57
  v_mul_f32 v58, v112, v58
  v_mul_f32 v59, v112, v59
  v_mul_f32 v60, v112, v60
  v_mul_f32 v61, v112, v61
  v_mul_f32 v62, v112, v62
  v_mul_f32 v63, v112, v63
  v_mul_f32 v64, v112, v64
  v_mul_f32 v65, v112, v65
  v_mul_f32 v66, v112, v66
  v_mul_f32 v67, v112, v67
  v_mul_f32 v68, v112, v68
  v_mul_f32 v69, v112, v69
  v_mul_f32 v70, v112, v70
  v_mul_f32 v71, v112, v71
  v_mul_f32 v72, v112, v72
  v_mul_f32 v73, v112, v73
  v_mul_f32 v74, v112, v74
  v_mul_f32 v75, v112, v75
  v_mul_f32 v76, v112, v76
  v_mul_f32 v77, v112, v77
  v_mul_f32 v78, v112, v78
  v_mul_f32 v79, v112, v79
  s_waitcnt lgkmcnt(6) vmcnt(1)
  v_mfma_f32_32x32x16_bf16 v[80:95], v[36:39], a[8:11], v[80:95]
  s_waitcnt lgkmcnt(4)
  v_mfma_f32_32x32x16_bf16 v[96:111], v[40:43], a[8:11], v[96:111]
  s_waitcnt lgkmcnt(2) vmcnt(0)
  v_mfma_f32_32x32x16_bf16 v[80:95], v[120:123], a[12:15], v[80:95]
  s_waitcnt lgkmcnt(0)
  v_mfma_f32_32x32x16_bf16 v[96:111], v[124:127], a[12:15], v[96:111]
  v_and_b32 v24, 31, v1
  v_mul_u32_u24 v24, 272, v24
  v_lshrrev_b32 v25, 5, v1
  v_lshl_add_u32 v24, v25, 4, v24
  s_mul_i32 s77, s72, 17408
  s_mul_i32 s78, s73, 8704
  s_add_u32 s77, s77, s78
  s_add_u32 s77, s77, 65536
  v_add_u32 v114, s77, v24
  s_nop 0
  v_fmac_f32 v48, v113, v80
  v_fmac_f32 v49, v113, v81
  v_fmac_f32 v50, v113, v82
  v_fmac_f32 v51, v113, v83
  ds_write_b128 v114, v[48:51]
  v_fmac_f32 v52, v113, v84
  v_fmac_f32 v53, v113, v85
  v_fmac_f32 v54, v113, v86
  v_fmac_f32 v55, v113, v87
  ds_write_b128 v114, v[52:55] offset:32
  v_fmac_f32 v56, v113, v88
  v_fmac_f32 v57, v113, v89
  v_fmac_f32 v58, v113, v90
  v_fmac_f32 v59, v113, v91
  ds_write_b128 v114, v[56:59] offset:64
  v_fmac_f32 v60, v113, v92
  v_fmac_f32 v61, v113, v93
  v_fmac_f32 v62, v113, v94
  v_fmac_f32 v63, v113, v95
  ds_write_b128 v114, v[60:63] offset:96
  v_fmac_f32 v64, v113, v96
  v_fmac_f32 v65, v113, v97
  v_fmac_f32 v66, v113, v98
  v_fmac_f32 v67, v113, v99
  ds_write_b128 v114, v[64:67] offset:128
  v_fmac_f32 v68, v113, v100
  v_fmac_f32 v69, v113, v101
  v_fmac_f32 v70, v113, v102
  v_fmac_f32 v71, v113, v103
  ds_write_b128 v114, v[68:71] offset:160
  v_fmac_f32 v72, v113, v104
  v_fmac_f32 v73, v113, v105
  v_fmac_f32 v74, v113, v106
  v_fmac_f32 v75, v113, v107
  ds_write_b128 v114, v[72:75] offset:192
  v_fmac_f32 v76, v113, v108
  v_fmac_f32 v77, v113, v109
  v_fmac_f32 v78, v113, v110
  v_fmac_f32 v79, v113, v111
  ds_write_b128 v114, v[76:79] offset:224
  v_lshrrev_b32 v24, 3, v1
  s_lshl_b32 s77, s3, 3
  v_add_u32 v24, s77, v24
  v_mul_u32_u24 v25, 272, v24
  v_and_b32 v26, 7, v1
  v_lshl_add_u32 v115, v26, 5, v25
  v_add_u32 v115, 65536, v115
  v_lshlrev_b32 v24, 10, v24
  v_lshl_add_u32 v24, v26, 4, v24
  s_lshl_b32 s77, s6, 16
  s_lshl_b32 s78, s7, 7
  s_add_u32 s77, s77, s78
  s_waitcnt lgkmcnt(0)
  s_barrier
  ds_read_b128 v[80:83], v115
  ds_read_b128 v[84:87], v115 offset:16
  ds_read_b128 v[88:91], v115 offset:17408
  ds_read_b128 v[92:95], v115 offset:17424
  ds_read_b128 v[96:99], v115 offset:34816
  ds_read_b128 v[100:103], v115 offset:34832
  ds_read_b128 v[104:107], v115 offset:52224
  ds_read_b128 v[108:111], v115 offset:52240
  s_waitcnt lgkmcnt(5)
  v_pk_add_f32 v[80:81], v[80:81], v[88:89]
  s_waitcnt lgkmcnt(1)
  v_pk_add_f32 v[96:97], v[96:97], v[104:105]
  v_pk_add_f32 v[82:83], v[82:83], v[90:91]
  v_pk_add_f32 v[98:99], v[98:99], v[106:107]
  v_pk_add_f32 v[84:85], v[84:85], v[92:93]
  s_waitcnt lgkmcnt(0)
  v_pk_add_f32 v[100:101], v[100:101], v[108:109]
  v_pk_add_f32 v[86:87], v[86:87], v[94:95]
  v_pk_add_f32 v[102:103], v[102:103], v[110:111]
  v_pk_add_f32 v[80:81], v[80:81], v[96:97]
  v_pk_add_f32 v[82:83], v[82:83], v[98:99]
  v_pk_add_f32 v[84:85], v[84:85], v[100:101]
  v_pk_add_f32 v[86:87], v[86:87], v[102:103]
  v_cvt_pk_bf16_f32 v88, v80, v81
  v_cvt_pk_bf16_f32 v89, v82, v83
  v_cvt_pk_bf16_f32 v90, v84, v85
  v_cvt_pk_bf16_f32 v91, v86, v87
  buffer_store_dwordx4 v[88:91], v24, s[36:39], s77 offen
  s_endpgm
.p2align 6
L_pathD:
  s_add_u32 m0, s89, 0
  s_nop 0
  buffer_load_dwordx4 v3, s[8:11], s48 offen lds
  buffer_load_dwordx4 v4, s[8:11], s48 offen offset:1024 lds
  s_cmp_eq_u32 s73, 0
  s_cselect_b64 s[44:45], s[16:17], s[20:21]
  s_mov_b32 s46, s18
  s_mov_b32 s47, 131072
  s_mul_i32 s56, s48, 1792
  s_mul_i32 s77, s72, 57344
  s_mul_i32 s78, s95, 896
  s_add_u32 s77, s77, s78
  s_mul_i32 s78, s96, 384
  s_add_u32 s77, s77, s78
  s_sub_u32 s77, s77, 512
  v_lshrrev_b32 v24, 3, v1
  v_mul_u32_u24 v24, 3584, v24
  v_and_b32 v25, 1, v1
  v_lshl_add_u32 v24, v25, 4, v24
  v_add_u32 v24, s77, v24
  v_bfe_u32 v25, v1, 1, 2
  v_bfe_u32 v26, v1, 4, 1
  v_lshlrev_b32 v26, 1, v26
  v_xor_b32 v25, v25, v26
  v_xor_b32 v25, s73, v25
  v_lshl_add_u32 v9, v25, 5, v24
  v_add_u32 v10, 27648, v9
  s_add_u32 m0, s88, 0
  s_nop 0
  buffer_load_dwordx4 v9, s[44:47], s56 offen lds
  buffer_load_dwordx4 v10, s[44:47], s56 offen offset:1024 lds
  s_add_u32 m0, s89, 4096
  s_nop 0
  buffer_load_dwordx4 v3, s[8:11], s49 offen lds
  buffer_load_dwordx4 v4, s[8:11], s49 offen offset:1024 lds
  s_mul_i32 s56, s48, 1792
  s_mul_i32 s57, s49, 1792
  s_mul_i32 s58, s50, 1792
  s_mul_i32 s59, s51, 1792
  s_mul_i32 s60, s52, 1792
  s_mul_i32 s61, s53, 1792
  s_mul_i32 s62, s54, 1792
  s_mul_i32 s63, s55, 1792
  s_add_u32 m0, s88, 16384
  s_nop 0
  buffer_load_dwordx4 v9, s[44:47], s57 offen lds
  buffer_load_dwordx4 v10, s[44:47], s57 offen offset:1024 lds
  s_add_u32 m0, s89, 8192
  s_nop 0
  buffer_load_dwordx4 v3, s[8:11], s50 offen lds
  buffer_load_dwordx4 v4, s[8:11], s50 offen offset:1024 lds
  s_lshr_b32 s90, s2, 3
  s_lshl_b32 s90, s90, 3
  s_add_u32 s90, s90, s3
  s_mov_b32 s74, 1069066811
  s_mov_b32 s75, 3216550459
  s_mov_b32 s76, 897988541
  s_mov_b32 s80, 4294901760
  s_mov_b32 s81, 4294901760
  v_mov_b32 v23, 0
  s_and_b32 s99, s2, 1
  s_lshl_b32 s99, s99, 7
  s_lshl_b32 s77, s4, 4
  s_add_u32 s77, s77, s5
  s_lshl_b32 s77, s77, 7
  s_add_u32 s2, s77, 11599872
  v_and_b32 v24, 31, v1
  v_bfe_u32 v25, v1, 1, 3
  v_lshrrev_b32 v26, 5, v1
  v_xor_b32 v25, v25, v26
  v_lshlrev_b32 v24, 7, v24
  s_lshl_b32 s77, s72, 14
  s_add_u32 s77, s77, 65536
  v_add_u32 v24, s77, v24
  v_xor_b32 v27, 0, v25
  v_lshl_add_u32 v5, v27, 4, v24
  v_xor_b32 v27, 2, v25
  v_lshl_add_u32 v6, v27, 4, v24
  v_xor_b32 v27, 4, v25
  v_lshl_add_u32 v7, v27, 4, v24
  v_xor_b32 v27, 6, v25
  v_lshl_add_u32 v8, v27, 4, v24
  v_lshrrev_b32 v24, 5, v1
  v_bfe_u32 v25, v1, 2, 2
  v_lshl_add_u32 v21, v24, 3, v25
  v_and_b32 v26, 3, v1
  v_and_b32 v27, 1, v26
  v_lshrrev_b32 v25, 1, v26
  v_lshl_or_b32 v27, v27, 1, v25
  v_lshlrev_b32 v24, 7, v21
  v_bfe_u32 v25, v1, 4, 1
  s_lshl_b32 s77, s73, 1
  v_lshl_add_u32 v24, v27, 3, v24
  v_lshl_add_u32 v24, v25, 11, v24
  v_bfe_u32 v26, v1, 3, 1
  v_lshl_or_b32 v26, v26, 1, v25
  v_xor_b32 v26, s77, v26
  v_lshl_add_u32 v13, v26, 5, v24
  v_xor_b32 v26, 1, v26
  v_lshl_add_u32 v14, v26, 5, v24
  v_add_u32 v15, 65536, v13
  v_add_u32 v16, 65536, v14
  s_lshl_b32 s77, s4, 7
  s_lshl_b32 s78, s5, 3
  s_add_u32 s77, s77, s78
  s_add_u32 s94, s77, s3
  s_lshl_b32 s77, s94, 10
  buffer_load_dwordx4 v[112:115], v2, s[8:11], s77 offen
  global_load_dwordx4 v[116:119], v2, s[0:1]
  s_waitcnt vmcnt(10)
  s_barrier
  ds_read_b128 a[0:3], v5
  ds_read_b128 a[4:7], v6
  ds_read_b128 a[8:11], v7
  ds_read_b128 a[12:15], v8
  s_waitcnt vmcnt(6)
  s_barrier
  ds_read_b64_tr_b16 v[28:29], v13
  ds_read_b64_tr_b16 v[30:31], v13 offset:512
  ds_read_b64_tr_b16 v[32:33], v14
  ds_read_b64_tr_b16 v[34:35], v14 offset:512
  ds_read_b64_tr_b16 v[36:37], v13 offset:4096
  ds_read_b64_tr_b16 v[38:39], v13 offset:4608
  s_waitcnt lgkmcnt(2)
  v_mfma_f32_32x32x16_bf16 v[48:63], v[28:31], a[0:3], 0
  ds_read_b64_tr_b16 v[40:41], v14 offset:4096
  ds_read_b64_tr_b16 v[42:43], v14 offset:4608
  s_add_u32 m0, s89, 12288
  s_nop 0
  buffer_load_dwordx4 v3, s[8:11], s51 offen lds
  ds_read_b128 a[16:19], v5 offset:4096
  v_mfma_f32_32x32x16_bf16 v[64:79], v[32:35], a[0:3], 0
  ds_read_b64_tr_b16 v[44:45], v13 offset:8192
  ds_read_b64_tr_b16 v[46:47], v13 offset:8704
  ds_read_b128 a[20:23], v6 offset:4096
  s_waitcnt lgkmcnt(4)
  v_mfma_f32_32x32x16_bf16 v[48:63], v[36:39], a[4:7], v[48:63]
  ds_read_b64_tr_b16 v[28:29], v14 offset:8192
  ds_read_b64_tr_b16 v[30:31], v14 offset:8704
  buffer_load_dwordx4 v4, s[8:11], s51 offen offset:1024 lds
  ds_read_b128 a[24:27], v7 offset:4096
  v_mfma_f32_32x32x16_bf16 v[64:79], v[40:43], a[4:7], v[64:79]
  ds_read_b64_tr_b16 v[32:33], v13 offset:12288
  ds_read_b64_tr_b16 v[34:35], v13 offset:12800
  ds_read_b128 a[28:31], v8 offset:4096
  s_waitcnt lgkmcnt(4)
  v_mfma_f32_32x32x16_bf16 v[48:63], v[44:47], a[8:11], v[48:63]
  ds_read_b64_tr_b16 v[36:37], v14 offset:12288
  ds_read_b64_tr_b16 v[38:39], v14 offset:12800
  s_add_u32 m0, s88, 32768
  s_nop 0
  buffer_load_dwordx4 v9, s[44:47], s58 offen lds
  v_mfma_f32_32x32x16_bf16 v[64:79], v[28:31], a[8:11], v[64:79]
  s_waitcnt vmcnt(5)
  s_barrier
  ds_read_b64_tr_b16 v[40:41], v13 offset:16384
  ds_read_b64_tr_b16 v[42:43], v13 offset:16896
  s_waitcnt lgkmcnt(2)
  v_mfma_f32_32x32x16_bf16 v[48:63], v[32:35], a[12:15], v[48:63]
  ds_read_b64_tr_b16 v[44:45], v14 offset:16384
  ds_read_b64_tr_b16 v[46:47], v14 offset:16896
  buffer_load_dwordx4 v10, s[44:47], s58 offen offset:1024 lds
  v_mfma_f32_32x32x16_bf16 v[64:79], v[36:39], a[12:15], v[64:79]
  ds_read_b64_tr_b16 v[28:29], v13 offset:20480
  ds_read_b64_tr_b16 v[30:31], v13 offset:20992
  s_waitcnt lgkmcnt(2)
  v_mfma_f32_32x32x16_bf16 v[48:63], v[40:43], a[16:19], v[48:63]
  ds_read_b64_tr_b16 v[32:33], v14 offset:20480
  ds_read_b64_tr_b16 v[34:35], v14 offset:20992
  s_add_u32 m0, s88, 49152
  s_nop 0
  buffer_load_dwordx4 v9, s[44:47], s59 offen lds
  ds_read_b128 a[32:35], v5 offset:8192
  s_mul_i32 s77, s72, 57344
  s_mul_i32 s78, s95, 896
  s_add_u32 s77, s77, s78
  s_mul_i32 s78, s96, 384
  s_add_u32 s77, s77, s78
  s_sub_u32 s77, s77, 384
  v_lshrrev_b32 v24, 3, v1
  v_mul_u32_u24 v24, 3584, v24
  v_and_b32 v25, 1, v1
  v_lshl_add_u32 v24, v25, 4, v24
  v_add_u32 v24, s77, v24
  v_bfe_u32 v25, v1, 1, 2
  v_bfe_u32 v26, v1, 4, 1
  v_lshlrev_b32 v26, 1, v26
  v_xor_b32 v25, v25, v26
  v_xor_b32 v25, s73, v25
  v_lshl_add_u32 v11, v25, 5, v24
  v_add_u32 v12, 27648, v11
  v_mfma_f32_32x32x16_bf16 v[64:79], v[44:47], a[16:19], v[64:79]
  ds_read_b64_tr_b16 v[36:37], v13 offset:24576
  ds_read_b64_tr_b16 v[38:39], v13 offset:25088
  ds_read_b128 a[36:39], v6 offset:8192
  s_waitcnt lgkmcnt(4)
  v_mfma_f32_32x32x16_bf16 v[48:63], v[28:31], a[20:23], v[48:63]
  ds_read_b64_tr_b16 v[40:41], v14 offset:24576
  ds_read_b64_tr_b16 v[42:43], v14 offset:25088
  buffer_load_dwordx4 v10, s[44:47], s59 offen offset:1024 lds
  ds_read_b128 a[40:43], v7 offset:8192
  v_mfma_f32_32x32x16_bf16 v[64:79], v[32:35], a[20:23], v[64:79]
  ds_read_b64_tr_b16 v[44:45], v13 offset:28672
  ds_read_b64_tr_b16 v[46:47], v13 offset:29184
  ds_read_b128 a[44:47], v8 offset:8192
  s_waitcnt lgkmcnt(4)
  v_mfma_f32_32x32x16_bf16 v[48:63], v[36:39], a[24:27], v[48:63]
  ds_read_b64_tr_b16 v[28:29], v14 offset:28672
  ds_read_b64_tr_b16 v[30:31], v14 offset:29184
  s_add_u32 m0, s89, 0
  s_nop 0
  buffer_load_dwordx4 v3, s[8:11], s52 offen lds
  v_mfma_f32_32x32x16_bf16 v[64:79], v[40:43], a[24:27], v[64:79]
  s_waitcnt vmcnt(3)
  s_barrier
  ds_read_b64_tr_b16 v[32:33], v13 offset:32768
  ds_read_b64_tr_b16 v[34:35], v13 offset:33280
  s_waitcnt lgkmcnt(2)
  v_mfma_f32_32x32x16_bf16 v[48:63], v[44:47], a[28:31], v[48:63]
  ds_read_b64_tr_b16 v[36:37], v14 offset:32768
  ds_read_b64_tr_b16 v[38:39], v14 offset:33280
  buffer_load_dwordx4 v4, s[8:11], s52 offen offset:1024 lds
  v_mfma_f32_32x32x16_bf16 v[64:79], v[28:31], a[28:31], v[64:79]
  ds_read_b64_tr_b16 v[40:41], v13 offset:36864
  ds_read_b64_tr_b16 v[42:43], v13 offset:37376
  s_waitcnt lgkmcnt(2)
  v_mfma_f32_32x32x16_bf16 v[48:63], v[32:35], a[32:35], v[48:63]
  ds_read_b64_tr_b16 v[44:45], v14 offset:36864
  ds_read_b64_tr_b16 v[46:47], v14 offset:37376
  s_add_u32 m0, s89, 4096
  s_nop 0
  buffer_load_dwordx4 v3, s[8:11], s53 offen lds
  ds_read_b128 a[48:51], v5 offset:12288
  v_mov_b32 v120, 0
  v_dot2c_f32_bf16 v120, v112, v116
  v_mfma_f32_32x32x16_bf16 v[64:79], v[36:39], a[32:35], v[64:79]
  ds_read_b64_tr_b16 v[28:29], v13 offset:40960
  ds_read_b64_tr_b16 v[30:31], v13 offset:41472
  ds_read_b128 a[52:55], v6 offset:12288
  v_dot2c_f32_bf16 v120, v113, v117
  s_waitcnt lgkmcnt(4)
  v_mfma_f32_32x32x16_bf16 v[48:63], v[40:43], a[36:39], v[48:63]
  ds_read_b64_tr_b16 v[32:33], v14 offset:40960
  ds_read_b64_tr_b16 v[34:35], v14 offset:41472
  buffer_load_dwordx4 v4, s[8:11], s53 offen offset:1024 lds
  ds_read_b128 a[56:59], v7 offset:12288
  v_dot2c_f32_bf16 v120, v114, v118
  v_mfma_f32_32x32x16_bf16 v[64:79], v[44:47], a[36:39], v[64:79]
  ds_read_b64_tr_b16 v[36:37], v13 offset:45056
  ds_read_b64_tr_b16 v[38:39], v13 offset:45568
  ds_read_b128 a[60:63], v8 offset:12288
  v_dot2c_f32_bf16 v120, v115, v119
  s_nop 2
  v_add_f32 v120, v120, v120 quad_perm:[1,0,3,2] row_mask:0xf bank_mask:0xf
  s_waitcnt lgkmcnt(4)
  v_mfma_f32_32x32x16_bf16 v[48:63], v[28:31], a[40:43], v[48:63]
  ds_read_b64_tr_b16 v[40:41], v14 offset:45056
  ds_read_b64_tr_b16 v[42:43], v14 offset:45568
  s_add_u32 m0, s88, 0
  s_nop 0
  buffer_load_dwordx4 v9, s[44:47], s60 offen lds
  v_add_f32 v120, v120, v120 quad_perm:[2,3,0,1] row_mask:0xf bank_mask:0xf
  v_mfma_f32_32x32x16_bf16 v[64:79], v[32:35], a[40:43], v[64:79]
  s_waitcnt vmcnt(3)
  s_barrier
  ds_read_b64_tr_b16 v[44:45], v13 offset:49152
  ds_read_b64_tr_b16 v[46:47], v13 offset:49664
  v_add_f32 v120, v120, v120 row_half_mirror row_mask:0xf bank_mask:0xf
  s_waitcnt lgkmcnt(2)
  v_mfma_f32_32x32x16_bf16 v[48:63], v[36:39], a[44:47], v[48:63]
  ds_read_b64_tr_b16 v[28:29], v14 offset:49152
  ds_read_b64_tr_b16 v[30:31], v14 offset:49664
  buffer_load_dwordx4 v10, s[44:47], s60 offen offset:1024 lds
  v_add_f32 v120, v120, v120 row_mirror row_mask:0xf bank_mask:0xf
  s_nop 1
  v_add_f32 v120, v120, v120 row_bcast:15 row_mask:0xa bank_mask:0xf
  v_mfma_f32_32x32x16_bf16 v[64:79], v[40:43], a[44:47], v[64:79]
  ds_read_b64_tr_b16 v[32:33], v13 offset:53248
  ds_read_b64_tr_b16 v[34:35], v13 offset:53760
  v_add_f32 v120, v120, v120 row_bcast:31 row_mask:0xc bank_mask:0xf
  s_waitcnt lgkmcnt(2)
  v_mfma_f32_32x32x16_bf16 v[48:63], v[44:47], a[48:51], v[48:63]
  ds_read_b64_tr_b16 v[36:37], v14 offset:53248
  ds_read_b64_tr_b16 v[38:39], v14 offset:53760
  s_add_u32 m0, s89, 8192
  s_nop 0
  buffer_load_dwordx4 v3, s[8:11], s54 offen lds
  ds_read_b128 a[64:67], v5
  v_and_b32 v26, 3, v1
  v_and_b32 v27, 1, v26
  v_lshrrev_b32 v25, 1, v26
  v_lshl_or_b32 v27, v27, 1, v25
  v_lshlrev_b32 v24, 7, v21
  v_bfe_u32 v25, v1, 4, 1
  s_lshl_b32 s77, s73, 1
  v_lshl_add_u32 v24, v27, 3, v24
  v_lshl_add_u32 v24, v25, 11, v24
  v_bfe_u32 v26, v1, 3, 1
  v_lshl_or_b32 v26, v26, 1, v25
  s_sub_u32 s77, s96, 2
  s_lshl_b32 s77, s77, 1
  s_add_u32 s77, s77, s73
  v_xor_b32 v26, s77, v26
  v_lshl_add_u32 v17, v26, 5, v24
  v_add_u32 v19, 65536, v17
  v_mul_f32 v120, s75, v120
  v_mfma_f32_32x32x16_bf16 v[64:79], v[28:31], a[48:51], v[64:79]
  ds_read_b64_tr_b16 v[40:41], v13 offset:57344
  ds_read_b64_tr_b16 v[42:43], v13 offset:57856
  ds_read_b128 a[68:71], v6
  v_exp_f32 v120, v120
  s_nop 0
  v_add_f32 v120, 1.0, v120
  s_waitcnt lgkmcnt(4)
  v_mfma_f32_32x32x16_bf16 v[48:63], v[32:35], a[52:55], v[48:63]
  ds_read_b64_tr_b16 v[44:45], v14 offset:57344
  ds_read_b64_tr_b16 v[46:47], v14 offset:57856
  buffer_load_dwordx4 v4, s[8:11], s54 offen offset:1024 lds
  ds_read_b128 a[72:75], v7
  v_rcp_f32 v120, v120
  v_mfma_f32_32x32x16_bf16 v[64:79], v[36:39], a[52:55], v[64:79]
  ds_read_b64_tr_b16 v[28:29], v13 offset:61440
  ds_read_b64_tr_b16 v[30:31], v13 offset:61952
  ds_read_b128 a[76:79], v8
  s_lshl_b32 s77, s94, 2
  s_add_u32 s77, s77, 11534336
  s_mov_b32 exec_lo, 0
  s_mov_b32 exec_hi, 0x80000000
  buffer_store_dword v120, v23, s[32:35], s77 offen sc1
  s_mov_b64 exec, -1
  s_waitcnt lgkmcnt(4)
  v_mfma_f32_32x32x16_bf16 v[48:63], v[40:43], a[56:59], v[48:63]
  ds_read_b64_tr_b16 v[32:33], v14 offset:61440
  ds_read_b64_tr_b16 v[34:35], v14 offset:61952
  s_add_u32 m0, s88, 16384
  s_nop 0
  buffer_load_dwordx4 v9, s[44:47], s61 offen lds
  v_mfma_f32_32x32x16_bf16 v[64:79], v[44:47], a[56:59], v[64:79]
  s_waitcnt vmcnt(4)
  s_barrier
  ds_read_b64_tr_b16 v[36:37], v13
  ds_read_b64_tr_b16 v[38:39], v13 offset:512
  s_waitcnt lgkmcnt(2)
  v_mfma_f32_32x32x16_bf16 v[48:63], v[28:31], a[60:63], v[48:63]
  ds_read_b64_tr_b16 v[40:41], v14
  ds_read_b64_tr_b16 v[42:43], v14 offset:512
  buffer_load_dwordx4 v10, s[44:47], s61 offen offset:1024 lds
  v_mfma_f32_32x32x16_bf16 v[64:79], v[32:35], a[60:63], v[64:79]
  ds_read_b64_tr_b16 v[44:45], v13 offset:4096
  ds_read_b64_tr_b16 v[46:47], v13 offset:4608
  s_waitcnt lgkmcnt(2)
  v_mfma_f32_32x32x16_bf16 v[48:63], v[36:39], a[64:67], v[48:63]
  ds_read_b64_tr_b16 v[28:29], v14 offset:4096
  ds_read_b64_tr_b16 v[30:31], v14 offset:4608
  s_add_u32 m0, s89, 12288
  s_nop 0
  buffer_load_dwordx4 v3, s[8:11], s55 offen lds
  ds_read_b128 a[80:83], v5 offset:4096
  v_mfma_f32_32x32x16_bf16 v[64:79], v[40:43], a[64:67], v[64:79]
  ds_read_b64_tr_b16 v[32:33], v13 offset:8192
  ds_read_b64_tr_b16 v[34:35], v13 offset:8704
  ds_read_b128 a[84:87], v6 offset:4096
  s_waitcnt lgkmcnt(4)
  v_mfma_f32_32x32x16_bf16 v[48:63], v[44:47], a[68:71], v[48:63]
  ds_read_b64_tr_b16 v[36:37], v14 offset:8192
  ds_read_b64_tr_b16 v[38:39], v14 offset:8704
  buffer_load_dwordx4 v4, s[8:11], s55 offen offset:1024 lds
  ds_read_b128 a[88:91], v7 offset:4096
  v_mfma_f32_32x32x16_bf16 v[64:79], v[28:31], a[68:71], v[64:79]
  ds_read_b64_tr_b16 v[40:41], v13 offset:12288
  ds_read_b64_tr_b16 v[42:43], v13 offset:12800
  ds_read_b128 a[92:95], v8 offset:4096
  s_waitcnt lgkmcnt(4)
  v_mfma_f32_32x32x16_bf16 v[48:63], v[32:35], a[72:75], v[48:63]
  ds_read_b64_tr_b16 v[44:45], v14 offset:12288
  ds_read_b64_tr_b16 v[46:47], v14 offset:12800
  s_add_u32 m0, s88, 32768
  s_nop 0
  buffer_load_dwordx4 v9, s[44:47], s62 offen lds
  v_mfma_f32_32x32x16_bf16 v[64:79], v[36:39], a[72:75], v[64:79]
  s_waitcnt vmcnt(3)
  s_barrier
  ds_read_b64_tr_b16 v[28:29], v13 offset:16384
  ds_read_b64_tr_b16 v[30:31], v13 offset:16896
  s_waitcnt lgkmcnt(2)
  v_mfma_f32_32x32x16_bf16 v[48:63], v[40:43], a[76:79], v[48:63]
  ds_read_b64_tr_b16 v[32:33], v14 offset:16384
  ds_read_b64_tr_b16 v[34:35], v14 offset:16896
  buffer_load_dwordx4 v10, s[44:47], s62 offen offset:1024 lds
  v_mfma_f32_32x32x16_bf16 v[64:79], v[44:47], a[76:79], v[64:79]
  ds_read_b64_tr_b16 v[36:37], v13 offset:20480
  ds_read_b64_tr_b16 v[38:39], v13 offset:20992
  s_waitcnt lgkmcnt(2)
  v_mfma_f32_32x32x16_bf16 v[48:63], v[28:31], a[80:83], v[48:63]
  ds_read_b64_tr_b16 v[40:41], v14 offset:20480
  ds_read_b64_tr_b16 v[42:43], v14 offset:20992
  s_add_u32 m0, s88, 49152
  s_nop 0
  buffer_load_dwordx4 v9, s[44:47], s63 offen lds
  ds_read_b128 a[96:99], v5 offset:8192
  v_mfma_f32_32x32x16_bf16 v[64:79], v[32:35], a[80:83], v[64:79]
  ds_read_b64_tr_b16 v[44:45], v13 offset:24576
  ds_read_b64_tr_b16 v[46:47], v13 offset:25088
  ds_read_b128 a[100:103], v6 offset:8192
  s_waitcnt lgkmcnt(4)
  v_mfma_f32_32x32x16_bf16 v[48:63], v[36:39], a[84:87], v[48:63]
  ds_read_b64_tr_b16 v[28:29], v14 offset:24576
  ds_read_b64_tr_b16 v[30:31], v14 offset:25088
  buffer_load_dwordx4 v10, s[44:47], s63 offen offset:1024 lds
  ds_read_b128 a[104:107], v7 offset:8192
  v_mfma_f32_32x32x16_bf16 v[64:79], v[40:43], a[84:87], v[64:79]
  ds_read_b64_tr_b16 v[32:33], v13 offset:28672
  ds_read_b64_tr_b16 v[34:35], v13 offset:29184
  ds_read_b128 a[108:111], v8 offset:8192
  s_waitcnt lgkmcnt(4)
  v_mfma_f32_32x32x16_bf16 v[48:63], v[44:47], a[88:91], v[48:63]
  ds_read_b64_tr_b16 v[36:37], v14 offset:28672
  ds_read_b64_tr_b16 v[38:39], v14 offset:29184
  buffer_load_dwordx2 v[126:127], v23, s[40:43], s99 offen sc1
  v_mfma_f32_32x32x16_bf16 v[64:79], v[28:31], a[88:91], v[64:79]
  s_waitcnt vmcnt(3)
  s_barrier
  ds_read_b64_tr_b16 v[40:41], v13 offset:32768
  ds_read_b64_tr_b16 v[42:43], v13 offset:33280
  s_waitcnt lgkmcnt(2)
  v_mfma_f32_32x32x16_bf16 v[48:63], v[32:35], a[92:95], v[48:63]
  ds_read_b64_tr_b16 v[44:45], v14 offset:32768
  ds_read_b64_tr_b16 v[46:47], v14 offset:33280
  s_cmp_eq_u32 s73, 0
  s_cselect_b64 s[44:45], s[16:17], s[20:21]
  s_mov_b32 s46, s18
  s_mov_b32 s47, 131072
  s_add_u32 m0, s88, 0
  s_nop 0
  buffer_load_dwordx4 v11, s[44:47], s56 offen lds
  v_mfma_f32_32x32x16_bf16 v[64:79], v[36:39], a[92:95], v[64:79]
  ds_read_b64_tr_b16 v[28:29], v13 offset:36864
  ds_read_b64_tr_b16 v[30:31], v13 offset:37376
  s_waitcnt lgkmcnt(2)
  v_mfma_f32_32x32x16_bf16 v[48:63], v[40:43], a[96:99], v[48:63]
  ds_read_b64_tr_b16 v[32:33], v14 offset:36864
  ds_read_b64_tr_b16 v[34:35], v14 offset:37376
  buffer_load_dwordx4 v12, s[44:47], s56 offen offset:1024 lds
  ds_read_b128 a[112:115], v5 offset:12288
  s_lshl_b32 s78, s73, 11
  s_sub_u32 s77, s96, 2
  s_mul_i32 s97, s77, 12288
  s_add_u32 s97, s97, s78
  s_lshl_b32 s98, s77, 11
  s_lshl_b32 s78, s73, 10
  s_add_u32 s98, s98, s78
  v_mfma_f32_32x32x16_bf16 v[64:79], v[44:47], a[96:99], v[64:79]
  ds_read_b64_tr_b16 v[36:37], v13 offset:40960
  ds_read_b64_tr_b16 v[38:39], v13 offset:41472
  ds_read_b128 a[116:119], v6 offset:12288
  s_waitcnt lgkmcnt(4)
  v_mfma_f32_32x32x16_bf16 v[48:63], v[28:31], a[100:103], v[48:63]
  ds_read_b64_tr_b16 v[40:41], v14 offset:40960
  ds_read_b64_tr_b16 v[42:43], v14 offset:41472
  ds_read_b128 a[120:123], v7 offset:12288
  v_mfma_f32_32x32x16_bf16 v[64:79], v[32:35], a[100:103], v[64:79]
  ds_read_b64_tr_b16 v[44:45], v13 offset:45056
  ds_read_b64_tr_b16 v[46:47], v13 offset:45568
  ds_read_b128 a[124:127], v8 offset:12288
  s_waitcnt lgkmcnt(4)
  v_mfma_f32_32x32x16_bf16 v[48:63], v[36:39], a[104:107], v[48:63]
  ds_read_b64_tr_b16 v[28:29], v14 offset:45056
  ds_read_b64_tr_b16 v[30:31], v14 offset:45568
  v_mfma_f32_32x32x16_bf16 v[64:79], v[40:43], a[104:107], v[64:79]
  s_waitcnt vmcnt(3)
  s_barrier
  ds_read_b64_tr_b16 v[32:33], v13 offset:49152
  ds_read_b64_tr_b16 v[34:35], v13 offset:49664
  s_waitcnt lgkmcnt(2)
  v_mfma_f32_32x32x16_bf16 v[48:63], v[44:47], a[108:111], v[48:63]
  ds_read_b64_tr_b16 v[36:37], v14 offset:49152
  ds_read_b64_tr_b16 v[38:39], v14 offset:49664
  s_add_u32 m0, s88, 16384
  s_nop 0
  buffer_load_dwordx4 v11, s[44:47], s57 offen lds
  v_mfma_f32_32x32x16_bf16 v[64:79], v[28:31], a[108:111], v[64:79]
  ds_read_b64_tr_b16 v[40:41], v13 offset:53248
  ds_read_b64_tr_b16 v[42:43], v13 offset:53760
  s_waitcnt lgkmcnt(2)
  v_mfma_f32_32x32x16_bf16 v[48:63], v[32:35], a[112:115], v[48:63]
  ds_read_b64_tr_b16 v[44:45], v14 offset:53248
  ds_read_b64_tr_b16 v[46:47], v14 offset:53760
  buffer_load_dwordx4 v12, s[44:47], s57 offen offset:1024 lds
  v_mfma_f32_32x32x16_bf16 v[64:79], v[36:39], a[112:115], v[64:79]
  ds_read_b64_tr_b16 v[28:29], v13 offset:57344
  ds_read_b64_tr_b16 v[30:31], v13 offset:57856
  s_waitcnt lgkmcnt(2)
  v_mfma_f32_32x32x16_bf16 v[48:63], v[40:43], a[116:119], v[48:63]
  ds_read_b64_tr_b16 v[32:33], v14 offset:57344
  ds_read_b64_tr_b16 v[34:35], v14 offset:57856
  v_mfma_f32_32x32x16_bf16 v[64:79], v[44:47], a[116:119], v[64:79]
  ds_read_b64_tr_b16 v[36:37], v13 offset:61440
  ds_read_b64_tr_b16 v[38:39], v13 offset:61952
  s_waitcnt lgkmcnt(2)
  v_mfma_f32_32x32x16_bf16 v[48:63], v[28:31], a[120:123], v[48:63]
  ds_read_b64_tr_b16 v[40:41], v14 offset:61440
  ds_read_b64_tr_b16 v[42:43], v14 offset:61952
  s_waitcnt vmcnt(4)
  v_cmp_ne_u32 vcc, 0, v126
  s_mov_b32 s87, 0
  s_cmp_lg_u64 vcc, 0
  s_cbranch_scc1 LD_nonce_done
LD_nonce:
  s_sleep 1
  buffer_load_dwordx2 v[126:127], v23, s[40:43], s99 offen sc1
  s_waitcnt vmcnt(0)
  v_cmp_ne_u32 vcc, 0, v126
  s_add_u32 s87, s87, 1
  s_cmp_ge_u32 s87, 262144
  s_cbranch_scc1 LD_nonce_done
  s_cmp_eq_u64 vcc, 0
  s_cbranch_scc1 LD_nonce
LD_nonce_done:
  s_nop 0
  v_readfirstlane_b32 s82, v126
  v_readfirstlane_b32 s83, v127
  s_nop 3
  v_mfma_f32_32x32x16_bf16 v[64:79], v[32:35], a[120:123], v[64:79]
  s_waitcnt vmcnt(2)
  s_barrier
  ds_read_b64_tr_b16 v[44:45], v13
  ds_read_b64_tr_b16 v[46:47], v13 offset:512
  s_waitcnt lgkmcnt(2)
  v_mfma_f32_32x32x16_bf16 v[48:63], v[36:39], a[124:127], v[48:63]
  ds_read_b64_tr_b16 v[28:29], v14
  ds_read_b64_tr_b16 v[30:31], v14 offset:512
  s_add_u32 m0, s88, 32768
  s_nop 0
  buffer_load_dwordx4 v11, s[44:47], s58 offen lds
  v_mfma_f32_32x32x16_bf16 v[64:79], v[40:43], a[124:127], v[64:79]
  ds_read_b64_tr_b16 v[32:33], v13 offset:4096
  ds_read_b64_tr_b16 v[34:35], v13 offset:4608
  s_waitcnt lgkmcnt(2)
  v_mfma_f32_32x32x16_bf16 v[80:95], v[44:47], a[0:3], 0
  ds_read_b64_tr_b16 v[36:37], v14 offset:4096
  ds_read_b64_tr_b16 v[38:39], v14 offset:4608
  buffer_load_dwordx4 v12, s[44:47], s58 offen offset:1024 lds
  v_mfma_f32_32x32x16_bf16 v[96:111], v[28:31], a[0:3], 0
  ds_read_b64_tr_b16 v[40:41], v13 offset:8192
  ds_read_b64_tr_b16 v[42:43], v13 offset:8704
  s_waitcnt lgkmcnt(2)
  v_mfma_f32_32x32x16_bf16 v[80:95], v[32:35], a[4:7], v[80:95]
  ds_read_b64_tr_b16 v[44:45], v14 offset:8192
  ds_read_b64_tr_b16 v[46:47], v14 offset:8704
  v_lshlrev_b32 v24, 7, v1
  s_mul_i32 s77, s90, 7168
  s_add_u32 s77, s77, 0
  s_mov_b32 exec_lo, 0xff
  s_mov_b32 exec_hi, 0x0
  buffer_load_dword v23, v24, s[24:27], s77 offen
  s_mov_b64 exec, -1
  v_mfma_f32_32x32x16_bf16 v[96:111], v[36:39], a[4:7], v[96:111]
  ds_read_b64_tr_b16 v[28:29], v13 offset:12288
  ds_read_b64_tr_b16 v[30:31], v13 offset:12800
  v_mul_f32 v112, s75, v48
  v_mul_f32 v113, s75, v49
  v_mul_f32 v114, s75, v50
  s_waitcnt lgkmcnt(2)
  v_mfma_f32_32x32x16_bf16 v[80:95], v[40:43], a[8:11], v[80:95]
  ds_read_b64_tr_b16 v[32:33], v14 offset:12288
  ds_read_b64_tr_b16 v[34:35], v14 offset:12800
  v_mul_f32 v115, s75, v51
  v_exp_f32 v112, v112
  v_mfma_f32_32x32x16_bf16 v[96:111], v[44:47], a[8:11], v[96:111]
  s_waitcnt vmcnt(3)
  s_barrier
  ds_read_b64_tr_b16 v[36:37], v13 offset:16384
  ds_read_b64_tr_b16 v[38:39], v13 offset:16896
  v_exp_f32 v113, v113
  v_exp_f32 v114, v114
  v_exp_f32 v115, v115
  s_waitcnt lgkmcnt(2)
  v_mfma_f32_32x32x16_bf16 v[80:95], v[28:31], a[12:15], v[80:95]
  ds_read_b64_tr_b16 v[40:41], v14 offset:16384
  ds_read_b64_tr_b16 v[42:43], v14 offset:16896
  s_add_u32 m0, s88, 49152
  s_nop 0
  buffer_load_dwordx4 v11, s[44:47], s59 offen lds
  v_mul_f32 v56, v48, v56
  v_mul_f32 v57, v49, v57
  v_mfma_f32_32x32x16_bf16 v[96:111], v[32:35], a[12:15], v[96:111]
  ds_read_b64_tr_b16 v[44:45], v13 offset:20480
  ds_read_b64_tr_b16 v[46:47], v13 offset:20992
  v_mul_f32 v58, v50, v58
  v_mul_f32 v59, v51, v59
  s_waitcnt lgkmcnt(2)
  v_mfma_f32_32x32x16_bf16 v[80:95], v[36:39], a[16:19], v[80:95]
  ds_read_b64_tr_b16 v[28:29], v14 offset:20480
  ds_read_b64_tr_b16 v[30:31], v14 offset:20992
  buffer_load_dwordx4 v12, s[44:47], s59 offen offset:1024 lds
  v_add_f32 v112, 1.0, v112
  v_add_f32 v113, 1.0, v113
  v_add_f32 v114, 1.0, v114
  v_mfma_f32_32x32x16_bf16 v[96:111], v[40:43], a[16:19], v[96:111]
  ds_read_b64_tr_b16 v[32:33], v13 offset:24576
  ds_read_b64_tr_b16 v[34:35], v13 offset:25088
  v_add_f32 v115, 1.0, v115
  v_rcp_f32 v112, v112
  s_waitcnt lgkmcnt(2)
  v_mfma_f32_32x32x16_bf16 v[80:95], v[44:47], a[20:23], v[80:95]
  ds_read_b64_tr_b16 v[36:37], v14 offset:24576
  ds_read_b64_tr_b16 v[38:39], v14 offset:25088
  v_lshlrev_b32 v24, 7, v1
  s_mul_i32 s77, s90, 7168
  s_add_u32 s77, s77, 1024
  s_mov_b32 exec_lo, 0xff
  s_mov_b32 exec_hi, 0x0
  buffer_load_dword v23, v24, s[24:27], s77 offen
  s_mov_b64 exec, -1
  s_mul_i32 s77, s72, 57344
  s_mul_i32 s78, s95, 896
  s_add_u32 s77, s77, s78
  s_add_u32 s77, s77, 512
  v_lshrrev_b32 v24, 3, v1
  v_mul_u32_u24 v24, 3584, v24
  v_and_b32 v25, 1, v1
  v_lshl_add_u32 v24, v25, 4, v24
  v_add_u32 v24, s77, v24
  v_bfe_u32 v25, v1, 1, 2
  v_bfe_u32 v26, v1, 4, 1
  v_lshlrev_b32 v26, 1, v26
  v_xor_b32 v25, v25, v26
  v_xor_b32 v25, s73, v25
  v_lshl_add_u32 v9, v25, 5, v24
  v_add_u32 v10, 27648, v9
  v_rcp_f32 v113, v113
  v_rcp_f32 v114, v114
  v_mfma_f32_32x32x16_bf16 v[96:111], v[28:31], a[20:23], v[96:111]
  ds_read_b64_tr_b16 v[40:41], v13 offset:28672
  ds_read_b64_tr_b16 v[42:43], v13 offset:29184
  v_rcp_f32 v115, v115
  v_mul_f32 v56, v112, v56
  v_mul_f32 v57, v113, v57
  s_waitcnt lgkmcnt(2)
  v_mfma_f32_32x32x16_bf16 v[80:95], v[32:35], a[24:27], v[80:95]
  ds_read_b64_tr_b16 v[44:45], v14 offset:28672
  ds_read_b64_tr_b16 v[46:47], v14 offset:29184
  v_mul_f32 v58, v114, v58
  v_mul_f32 v59, v115, v59
  v_mfma_f32_32x32x16_bf16 v[96:111], v[36:39], a[24:27], v[96:111]
  s_waitcnt vmcnt(4)
  s_barrier
  ds_read_b64_tr_b16 v[28:29], v13 offset:32768
  ds_read_b64_tr_b16 v[30:31], v13 offset:33280
  v_mul_f32 v116, s75, v52
  v_mul_f32 v117, s75, v53
  s_waitcnt lgkmcnt(2)
  v_mfma_f32_32x32x16_bf16 v[80:95], v[40:43], a[28:31], v[80:95]
  ds_read_b64_tr_b16 v[32:33], v14 offset:32768
  ds_read_b64_tr_b16 v[34:35], v14 offset:33280
  s_add_u32 m0, s88, 0
  s_nop 0
  buffer_load_dwordx4 v11, s[44:47], s60 offen lds
  v_mul_f32 v118, s75, v54
  v_mul_f32 v119, s75, v55
  v_exp_f32 v116, v116
  v_mfma_f32_32x32x16_bf16 v[96:111], v[44:47], a[28:31], v[96:111]
  ds_read_b64_tr_b16 v[36:37], v13 offset:36864
  ds_read_b64_tr_b16 v[38:39], v13 offset:37376
  v_exp_f32 v117, v117
  v_exp_f32 v118, v118
  s_waitcnt lgkmcnt(2)
  v_mfma_f32_32x32x16_bf16 v[80:95], v[28:31], a[32:35], v[80:95]
  ds_read_b64_tr_b16 v[40:41], v14 offset:36864
  ds_read_b64_tr_b16 v[42:43], v14 offset:37376
  buffer_load_dwordx4 v12, s[44:47], s60 offen offset:1024 lds
  v_exp_f32 v119, v119
  v_mul_f32 v60, v52, v60
  v_mfma_f32_32x32x16_bf16 v[96:111], v[32:35], a[32:35], v[96:111]
  ds_read_b64_tr_b16 v[44:45], v13 offset:40960
  ds_read_b64_tr_b16 v[46:47], v13 offset:41472
  v_mul_f32 v61, v53, v61
  v_mul_f32 v62, v54, v62
  v_mul_f32 v63, v55, v63
  s_waitcnt lgkmcnt(2)
  v_mfma_f32_32x32x16_bf16 v[80:95], v[36:39], a[36:39], v[80:95]
  ds_read_b64_tr_b16 v[28:29], v14 offset:40960
  ds_read_b64_tr_b16 v[30:31], v14 offset:41472
  v_lshlrev_b32 v24, 7, v1
  s_mul_i32 s77, s90, 7168
  s_add_u32 s77, s77, 2048
  s_mov_b32 exec_lo, 0xff
  s_mov_b32 exec_hi, 0x0
  buffer_load_dword v23, v24, s[24:27], s77 offen
  s_mov_b64 exec, -1
  v_add_f32 v116, 1.0, v116
  v_add_f32 v117, 1.0, v117
  v_mfma_f32_32x32x16_bf16 v[96:111], v[40:43], a[36:39], v[96:111]
  ds_read_b64_tr_b16 v[32:33], v13 offset:45056
  ds_read_b64_tr_b16 v[34:35], v13 offset:45568
  v_add_f32 v118, 1.0, v118
  v_add_f32 v119, 1.0, v119
  v_rcp_f32 v116, v116
  s_waitcnt lgkmcnt(2)
  v_mfma_f32_32x32x16_bf16 v[80:95], v[44:47], a[40:43], v[80:95]
  ds_read_b64_tr_b16 v[36:37], v14 offset:45056
  ds_read_b64_tr_b16 v[38:39], v14 offset:45568
  v_rcp_f32 v117, v117
  v_rcp_f32 v118, v118
  v_mfma_f32_32x32x16_bf16 v[96:111], v[28:31], a[40:43], v[96:111]
  s_waitcnt vmcnt(4)
  s_barrier
  ds_read_b64_tr_b16 v[40:41], v13 offset:49152
  ds_read_b64_tr_b16 v[42:43], v13 offset:49664
  v_rcp_f32 v119, v119
  v_mul_f32 v60, v116, v60
  s_waitcnt lgkmcnt(2)
  v_mfma_f32_32x32x16_bf16 v[80:95], v[32:35], a[44:47], v[80:95]
  ds_read_b64_tr_b16 v[44:45], v14 offset:49152
  ds_read_b64_tr_b16 v[46:47], v14 offset:49664
  s_add_u32 m0, s88, 16384
  s_nop 0
  buffer_load_dwordx4 v11, s[44:47], s61 offen lds
  v_mul_f32 v61, v117, v61
  v_mul_f32 v62, v118, v62
  v_mul_f32 v63, v119, v63
  v_mfma_f32_32x32x16_bf16 v[96:111], v[36:39], a[44:47], v[96:111]
  ds_read_b64_tr_b16 v[28:29], v13 offset:53248
  ds_read_b64_tr_b16 v[30:31], v13 offset:53760
  v_cvt_pk_bf16_f32 v48, v56, v57
  v_cvt_pk_bf16_f32 v49, v58, v59
  s_waitcnt lgkmcnt(2)
  v_mfma_f32_32x32x16_bf16 v[80:95], v[40:43], a[48:51], v[80:95]
  ds_read_b64_tr_b16 v[32:33], v14 offset:53248
  ds_read_b64_tr_b16 v[34:35], v14 offset:53760
  buffer_load_dwordx4 v12, s[44:47], s61 offen offset:1024 lds
  v_cvt_pk_bf16_f32 v50, v60, v61
  v_cvt_pk_bf16_f32 v51, v62, v63
  v_mfma_f32_32x32x16_bf16 v[96:111], v[44:47], a[48:51], v[96:111]
  ds_read_b64_tr_b16 v[36:37], v13 offset:57344
  ds_read_b64_tr_b16 v[38:39], v13 offset:57856
  s_add_u32 s77, s84, s97
  s_add_u32 s77, s77, 8192
  buffer_store_dwordx4 v[48:51], v2, s[32:35], s77 offen sc1
  v_mul_f32 v112, s75, v64
  v_mul_f32 v113, s75, v65
  s_waitcnt lgkmcnt(2)
  v_mfma_f32_32x32x16_bf16 v[80:95], v[28:31], a[52:55], v[80:95]
  ds_read_b64_tr_b16 v[40:41], v14 offset:57344
  ds_read_b64_tr_b16 v[42:43], v14 offset:57856
  v_lshlrev_b32 v24, 7, v1
  s_mul_i32 s77, s90, 7168
  s_add_u32 s77, s77, 3072
  s_mov_b32 exec_lo, 0xff
  s_mov_b32 exec_hi, 0x0
  buffer_load_dword v23, v24, s[24:27], s77 offen
  s_mov_b64 exec, -1
  v_mul_f32 v114, s75, v66
  v_mul_f32 v115, s75, v67
  v_mfma_f32_32x32x16_bf16 v[96:111], v[32:35], a[52:55], v[96:111]
  ds_read_b64_tr_b16 v[44:45], v13 offset:61440
  ds_read_b64_tr_b16 v[46:47], v13 offset:61952
  v_exp_f32 v112, v112
  v_exp_f32 v113, v113
  s_waitcnt lgkmcnt(2)
  v_mfma_f32_32x32x16_bf16 v[80:95], v[36:39], a[56:59], v[80:95]
  ds_read_b64_tr_b16 v[28:29], v14 offset:61440
  ds_read_b64_tr_b16 v[30:31], v14 offset:61952
  v_exp_f32 v114, v114
  v_exp_f32 v115, v115
  v_mul_f32 v72, v64, v72
  v_mfma_f32_32x32x16_bf16 v[96:111], v[40:43], a[56:59], v[96:111]
  s_waitcnt vmcnt(5)
  s_barrier
  ds_read_b64_tr_b16 v[32:33], v13
  ds_read_b64_tr_b16 v[34:35], v13 offset:512
  v_mul_f32 v73, v65, v73
  v_mul_f32 v74, v66, v74
  s_waitcnt lgkmcnt(2)
  v_mfma_f32_32x32x16_bf16 v[80:95], v[44:47], a[60:63], v[80:95]
  ds_read_b64_tr_b16 v[36:37], v14
  ds_read_b64_tr_b16 v[38:39], v14 offset:512
  s_add_u32 m0, s88, 32768
  s_nop 0
  buffer_load_dwordx4 v11, s[44:47], s62 offen lds
  v_mul_f32 v75, v67, v75
  v_add_f32 v112, 1.0, v112
  v_mfma_f32_32x32x16_bf16 v[96:111], v[28:31], a[60:63], v[96:111]
  ds_read_b64_tr_b16 v[40:41], v13 offset:4096
  ds_read_b64_tr_b16 v[42:43], v13 offset:4608
  v_add_f32 v113, 1.0, v113
  v_add_f32 v114, 1.0, v114
  v_add_f32 v115, 1.0, v115
  s_waitcnt lgkmcnt(2)
  v_mfma_f32_32x32x16_bf16 v[80:95], v[32:35], a[64:67], v[80:95]
  ds_read_b64_tr_b16 v[44:45], v14 offset:4096
  ds_read_b64_tr_b16 v[46:47], v14 offset:4608
  buffer_load_dwordx4 v12, s[44:47], s62 offen offset:1024 lds
  v_rcp_f32 v112, v112
  v_rcp_f32 v113, v113
  v_mfma_f32_32x32x16_bf16 v[96:111], v[36:39], a[64:67], v[96:111]
  ds_read_b64_tr_b16 v[28:29], v13 offset:8192
  ds_read_b64_tr_b16 v[30:31], v13 offset:8704
  v_rcp_f32 v114, v114
  v_rcp_f32 v115, v115
  v_mul_f32 v72, v112, v72
  s_waitcnt lgkmcnt(2)
  v_mfma_f32_32x32x16_bf16 v[80:95], v[40:43], a[68:71], v[80:95]
  ds_read_b64_tr_b16 v[32:33], v14 offset:8192
  ds_read_b64_tr_b16 v[34:35], v14 offset:8704
  v_lshlrev_b32 v24, 7, v1
  s_mul_i32 s77, s90, 7168
  s_add_u32 s77, s77, 4096
  s_mov_b32 exec_lo, 0xff
  s_mov_b32 exec_hi, 0x0
  buffer_load_dword v23, v24, s[24:27], s77 offen
  s_mov_b64 exec, -1
  v_mul_f32 v73, v113, v73
  v_mul_f32 v74, v114, v74
  v_mfma_f32_32x32x16_bf16 v[96:111], v[44:47], a[68:71], v[96:111]
  ds_read_b64_tr_b16 v[36:37], v13 offset:12288
  ds_read_b64_tr_b16 v[38:39], v13 offset:12800
  v_mul_f32 v75, v115, v75
  v_mul_f32 v116, s75, v68
  s_waitcnt lgkmcnt(2)
  v_mfma_f32_32x32x16_bf16 v[80:95], v[28:31], a[72:75], v[80:95]
  ds_read_b64_tr_b16 v[40:41], v14 offset:12288
  ds_read_b64_tr_b16 v[42:43], v14 offset:12800
  v_mul_f32 v117, s75, v69
  v_mul_f32 v118, s75, v70
  v_mul_f32 v119, s75, v71
  v_mfma_f32_32x32x16_bf16 v[96:111], v[32:35], a[72:75], v[96:111]
  s_waitcnt vmcnt(5)
  s_barrier
  ds_read_b64_tr_b16 v[44:45], v13 offset:16384
  ds_read_b64_tr_b16 v[46:47], v13 offset:16896
  v_exp_f32 v116, v116
  v_exp_f32 v117, v117
  s_waitcnt lgkmcnt(2)
  v_mfma_f32_32x32x16_bf16 v[80:95], v[36:39], a[76:79], v[80:95]
  ds_read_b64_tr_b16 v[28:29], v14 offset:16384
  ds_read_b64_tr_b16 v[30:31], v14 offset:16896
  s_add_u32 m0, s88, 49152
  s_nop 0
  buffer_load_dwordx4 v11, s[44:47], s63 offen lds
  v_exp_f32 v118, v118
  v_exp_f32 v119, v119
  v_mfma_f32_32x32x16_bf16 v[96:111], v[40:43], a[76:79], v[96:111]
  ds_read_b64_tr_b16 v[32:33], v13 offset:20480
  ds_read_b64_tr_b16 v[34:35], v13 offset:20992
  v_mul_f32 v76, v68, v76
  v_mul_f32 v77, v69, v77
  v_mul_f32 v78, v70, v78
  s_waitcnt lgkmcnt(2)
  v_mfma_f32_32x32x16_bf16 v[80:95], v[44:47], a[80:83], v[80:95]
  ds_read_b64_tr_b16 v[36:37], v14 offset:20480
  ds_read_b64_tr_b16 v[38:39], v14 offset:20992
  buffer_load_dwordx4 v12, s[44:47], s63 offen offset:1024 lds
  v_mul_f32 v79, v71, v79
  v_add_f32 v116, 1.0, v116
  v_mfma_f32_32x32x16_bf16 v[96:111], v[28:31], a[80:83], v[96:111]
  ds_read_b64_tr_b16 v[40:41], v13 offset:24576
  ds_read_b64_tr_b16 v[42:43], v13 offset:25088
  v_add_f32 v117, 1.0, v117
  v_add_f32 v118, 1.0, v118
  s_waitcnt lgkmcnt(2)
  v_mfma_f32_32x32x16_bf16 v[80:95], v[32:35], a[84:87], v[80:95]
  ds_read_b64_tr_b16 v[44:45], v14 offset:24576
  ds_read_b64_tr_b16 v[46:47], v14 offset:25088
  v_lshlrev_b32 v24, 7, v1
  s_mul_i32 s77, s90, 7168
  s_add_u32 s77, s77, 5120
  s_mov_b32 exec_lo, 0xff
  s_mov_b32 exec_hi, 0x0
  buffer_load_dword v23, v24, s[24:27], s77 offen
  s_mov_b64 exec, -1
  v_add_f32 v119, 1.0, v119
  v_rcp_f32 v116, v116
  v_rcp_f32 v117, v117
  v_lshrrev_b32 v24, 3, v1
  v_and_b32 v25, 7, v1
  v_bfe_u32 v26, v1, 4, 1
  v_lshlrev_b32 v26, 2, v26
  v_xor_b32 v25, v25, v26
  v_lshlrev_b32 v25, 4, v25
  v_lshl_add_u32 v24, v24, 10, v25
  s_lshl_b32 s77, s73, 13
  s_lshl_b32 s78, s7, 7
  s_add_u32 s77, s77, s78
  v_add_u32 v3, s77, v24
  v_lshlrev_b32 v24, 7, v21
  v_and_b32 v25, 1, v1
  v_lshl_add_u32 v24, v25, 3, v24
  s_lshl_b32 s77, s72, 13
  v_add_u32 v24, s77, v24
  v_bfe_u32 v25, v1, 1, 1
  v_bfe_u32 v26, v1, 4, 1
  v_lshl_or_b32 v25, v26, 1, v25
  v_bfe_u32 v26, v1, 3, 1
  v_lshl_or_b32 v25, v26, 2, v25
  v_lshl_add_u32 v5, v25, 4, v24
  v_xor_b32 v25, 4, v25
  v_lshl_add_u32 v6, v25, 4, v24
  v_add_u32 v7, 65536, v5
  v_add_u32 v8, 65536, v6
  v_add_u32 v4, 131072, v5
  v_add_u32 v21, 131072, v6
  s_lshl_b32 s89, s72, 13
  s_lshl_b32 s77, s73, 10
  s_add_u32 s89, s89, s77
  s_mul_i32 s92, s72, 458752
  s_lshl_b32 s93, s72, 17
  s_and_b32 s91, s6, 3
  s_lshl_b32 s91, s91, 1
  s_add_u32 s91, s91, s7
  s_and_b32 s91, s91, 7
  s_xor_b32 s64, s91, 0
  s_lshl_b32 s64, s64, 14
  s_xor_b32 s65, s91, 1
  s_lshl_b32 s65, s65, 14
  s_xor_b32 s66, s91, 2
  s_lshl_b32 s66, s66, 14
  s_xor_b32 s67, s91, 3
  s_lshl_b32 s67, s67, 14
  s_xor_b32 s68, s91, 4
  s_lshl_b32 s68, s68, 14
  s_xor_b32 s69, s91, 5
  s_lshl_b32 s69, s69, 14
  s_xor_b32 s70, s91, 6
  s_lshl_b32 s70, s70, 14
  s_xor_b32 s71, s91, 7
  s_lshl_b32 s71, s71, 14
  s_lshl_b32 s77, s6, 1
  s_add_u32 s77, s77, s73
  s_mul_i32 s86, s77, 144
  s_mul_i32 s78, s72, 36
  s_add_u32 s86, s86, s78
  s_lshl_b32 s86, s86, 10
  v_mfma_f32_32x32x16_bf16 v[96:111], v[36:39], a[84:87], v[96:111]
  ds_read_b64_tr_b16 v[28:29], v13 offset:28672
  ds_read_b64_tr_b16 v[30:31], v13 offset:29184
  v_rcp_f32 v118, v118
  v_rcp_f32 v119, v119
  s_waitcnt lgkmcnt(2)
  v_mfma_f32_32x32x16_bf16 v[80:95], v[40:43], a[88:91], v[80:95]
  ds_read_b64_tr_b16 v[32:33], v14 offset:28672
  ds_read_b64_tr_b16 v[34:35], v14 offset:29184
  v_mul_f32 v76, v116, v76
  v_mul_f32 v77, v117, v77
  v_mfma_f32_32x32x16_bf16 v[96:111], v[44:47], a[88:91], v[96:111]
  s_waitcnt vmcnt(4)
  s_barrier
  ds_read_b64_tr_b16 v[36:37], v13 offset:32768
  ds_read_b64_tr_b16 v[38:39], v13 offset:33280
  v_mul_f32 v78, v118, v78
  v_mul_f32 v79, v119, v79
  v_cvt_pk_bf16_f32 v64, v72, v73
  s_waitcnt lgkmcnt(2)
  v_mfma_f32_32x32x16_bf16 v[80:95], v[28:31], a[92:95], v[80:95]
  ds_read_b64_tr_b16 v[40:41], v14 offset:32768
  ds_read_b64_tr_b16 v[42:43], v14 offset:33280
  s_cmp_eq_u32 s73, 0
  s_cselect_b64 s[44:45], s[16:17], s[20:21]
  s_mov_b32 s46, s18
  s_mov_b32 s47, 131072
  s_add_u32 m0, s88, 0
  s_nop 0
  buffer_load_dwordx4 v9, s[44:47], s56 offen lds
  v_cvt_pk_bf16_f32 v65, v74, v75
  v_cvt_pk_bf16_f32 v66, v76, v77
  v_mfma_f32_32x32x16_bf16 v[96:111], v[32:35], a[92:95], v[96:111]
  ds_read_b64_tr_b16 v[44:45], v13 offset:36864
  ds_read_b64_tr_b16 v[46:47], v13 offset:37376
  v_cvt_pk_bf16_f32 v67, v78, v79
  s_add_u32 s77, s84, s97
  s_add_u32 s77, s77, 8192
  buffer_store_dwordx4 v[64:67], v2, s[32:35], s77 offen offset:1024 sc1
  s_waitcnt lgkmcnt(2)
  v_mfma_f32_32x32x16_bf16 v[80:95], v[36:39], a[96:99], v[80:95]
  ds_read_b64_tr_b16 v[28:29], v14 offset:36864
  ds_read_b64_tr_b16 v[30:31], v14 offset:37376
  buffer_load_dwordx4 v10, s[44:47], s56 offen offset:1024 lds
  v_mfma_f32_32x32x16_bf16 v[96:111], v[40:43], a[96:99], v[96:111]
  ds_read_b64_tr_b16 v[32:33], v13 offset:40960
  ds_read_b64_tr_b16 v[34:35], v13 offset:41472
  s_waitcnt lgkmcnt(2)
  v_mfma_f32_32x32x16_bf16 v[80:95], v[44:47], a[100:103], v[80:95]
  ds_read_b64_tr_b16 v[36:37], v14 offset:40960
  ds_read_b64_tr_b16 v[38:39], v14 offset:41472
  v_lshlrev_b32 v24, 7, v1
  s_mul_i32 s77, s90, 7168
  s_add_u32 s77, s77, 6144
  s_mov_b32 exec_lo, 0xff
  s_mov_b32 exec_hi, 0x0
  buffer_load_dword v23, v24, s[24:27], s77 offen
  s_mov_b64 exec, -1
  v_mfma_f32_32x32x16_bf16 v[96:111], v[28:31], a[100:103], v[96:111]
  ds_read_b64_tr_b16 v[40:41], v13 offset:45056
  ds_read_b64_tr_b16 v[42:43], v13 offset:45568
  s_waitcnt lgkmcnt(2)
  v_mfma_f32_32x32x16_bf16 v[80:95], v[32:35], a[104:107], v[80:95]
  ds_read_b64_tr_b16 v[44:45], v14 offset:45056
  ds_read_b64_tr_b16 v[46:47], v14 offset:45568
  s_add_u32 m0, s89, 131072
  s_add_u32 s85, s64, s92
  buffer_load_dwordx4 v3, s[24:27], s85 offen lds
  v_mfma_f32_32x32x16_bf16 v[96:111], v[36:39], a[104:107], v[96:111]
  s_waitcnt vmcnt(6)
  s_barrier
  ds_read_b64_tr_b16 v[28:29], v13 offset:49152
  ds_read_b64_tr_b16 v[30:31], v13 offset:49664
  s_waitcnt lgkmcnt(2)
  v_mfma_f32_32x32x16_bf16 v[80:95], v[40:43], a[108:111], v[80:95]
  ds_read_b64_tr_b16 v[32:33], v14 offset:49152
  ds_read_b64_tr_b16 v[34:35], v14 offset:49664
  s_add_u32 m0, s89, 133120
  s_add_u32 s85, s65, s92
  buffer_load_dwordx4 v3, s[24:27], s85 offen lds
  v_mfma_f32_32x32x16_bf16 v[96:111], v[44:47], a[108:111], v[96:111]
  ds_read_b64_tr_b16 v[36:37], v13 offset:53248
  ds_read_b64_tr_b16 v[38:39], v13 offset:53760
  s_waitcnt lgkmcnt(2)
  v_mfma_f32_32x32x16_bf16 v[80:95], v[28:31], a[112:115], v[80:95]
  ds_read_b64_tr_b16 v[40:41], v14 offset:53248
  ds_read_b64_tr_b16 v[42:43], v14 offset:53760
  s_add_u32 m0, s89, 135168
  s_add_u32 s85, s66, s92
  buffer_load_dwordx4 v3, s[24:27], s85 offen lds
  v_mfma_f32_32x32x16_bf16 v[96:111], v[32:35], a[112:115], v[96:111]
  ds_read_b64_tr_b16 v[44:45], v13 offset:57344
  ds_read_b64_tr_b16 v[46:47], v13 offset:57856
  s_waitcnt lgkmcnt(2)
  v_mfma_f32_32x32x16_bf16 v[80:95], v[36:39], a[116:119], v[80:95]
  ds_read_b64_tr_b16 v[28:29], v14 offset:57344
  ds_read_b64_tr_b16 v[30:31], v14 offset:57856
  s_add_u32 m0, s89, 137216
  s_add_u32 s85, s67, s92
  buffer_load_dwordx4 v3, s[24:27], s85 offen lds
  v_mfma_f32_32x32x16_bf16 v[96:111], v[40:43], a[116:119], v[96:111]
  ds_read_b64_tr_b16 v[32:33], v13 offset:61440
  ds_read_b64_tr_b16 v[34:35], v13 offset:61952
  s_waitcnt lgkmcnt(2)
  v_mfma_f32_32x32x16_bf16 v[80:95], v[44:47], a[120:123], v[80:95]
  ds_read_b64_tr_b16 v[36:37], v14 offset:61440
  ds_read_b64_tr_b16 v[38:39], v14 offset:61952
  s_add_u32 m0, s88, 16384
  s_nop 0
  buffer_load_dwordx4 v9, s[44:47], s57 offen lds
  v_mfma_f32_32x32x16_bf16 v[96:111], v[28:31], a[120:123], v[96:111]
  s_waitcnt vmcnt(6)
  s_barrier
  ds_read_b64_tr_b16 v[40:41], v17
  ds_read_b64_tr_b16 v[42:43], v17 offset:512
  s_waitcnt lgkmcnt(2)
  v_mfma_f32_32x32x16_bf16 v[80:95], v[32:35], a[124:127], v[80:95]
  ds_read_b64_tr_b16 v[44:45], v17 offset:4096
  ds_read_b64_tr_b16 v[46:47], v17 offset:4608
  buffer_load_dwordx4 v10, s[44:47], s57 offen offset:1024 lds
  v_mfma_f32_32x32x16_bf16 v[96:111], v[36:39], a[124:127], v[96:111]
  ds_read_b64_tr_b16 v[28:29], v17 offset:8192
  ds_read_b64_tr_b16 v[30:31], v17 offset:8704
  s_waitcnt lgkmcnt(2)
  v_mfma_f32_32x32x16_bf16 v[48:63], v[40:43], a[0:3], 0
  ds_read_b64_tr_b16 v[32:33], v17 offset:12288
  ds_read_b64_tr_b16 v[34:35], v17 offset:12800
  v_lshlrev_b32 v24, 7, v1
  s_lshl_b32 s77, s90, 11
  s_add_u32 s77, s77, 0
  s_mov_b32 exec_lo, 0xff
  s_mov_b32 exec_hi, 0x0
  buffer_load_dword v23, v24, s[28:31], s77 offen
  s_mov_b64 exec, -1
  v_mfma_f32_32x32x16_bf16 v[48:63], v[44:47], a[4:7], v[48:63]
  s_waitcnt vmcnt(1)
  s_barrier
  ds_read_b64_tr_b16 v[36:37], v17 offset:16384
  ds_read_b64_tr_b16 v[38:39], v17 offset:16896
  s_add_u32 m0, s88, 32768
  s_nop 0
  buffer_load_dwordx4 v9, s[44:47], s58 offen lds
  s_waitcnt lgkmcnt(2)
  v_mfma_f32_32x32x16_bf16 v[48:63], v[28:31], a[8:11], v[48:63]
  ds_read_b64_tr_b16 v[40:41], v17 offset:20480
  ds_read_b64_tr_b16 v[42:43], v17 offset:20992
  buffer_load_dwordx4 v10, s[44:47], s58 offen offset:1024 lds
  v_mfma_f32_32x32x16_bf16 v[48:63], v[32:35], a[12:15], v[48:63]
  ds_read_b64_tr_b16 v[44:45], v17 offset:24576
  ds_read_b64_tr_b16 v[46:47], v17 offset:25088
  v_lshlrev_b32 v24, 7, v1
  s_lshl_b32 s77, s90, 11
  s_add_u32 s77, s77, 1024
  s_mov_b32 exec_lo, 0xff
  s_mov_b32 exec_hi, 0x0
  buffer_load_dword v23, v24, s[28:31], s77 offen
  s_mov_b64 exec, -1
  v_mul_f32 v112, s75, v80
  v_mul_f32 v113, s75, v81
  v_mul_f32 v114, s75, v82
  v_mul_f32 v115, s75, v83
  v_exp_f32 v112, v112
  v_exp_f32 v113, v113
  v_exp_f32 v114, v114
  s_waitcnt lgkmcnt(2)
  v_mfma_f32_32x32x16_bf16 v[48:63], v[36:39], a[16:19], v[48:63]
  ds_read_b64_tr_b16 v[28:29], v17 offset:28672
  ds_read_b64_tr_b16 v[30:31], v17 offset:29184
  s_add_u32 m0, s88, 49152
  s_nop 0
  buffer_load_dwordx4 v9, s[44:47], s59 offen lds
  v_exp_f32 v115, v115
  v_mul_f32 v88, v80, v88
  v_mul_f32 v89, v81, v89
  v_mul_f32 v90, v82, v90
  v_mul_f32 v91, v83, v91
  v_add_f32 v112, 1.0, v112
  v_mfma_f32_32x32x16_bf16 v[48:63], v[40:43], a[20:23], v[48:63]
  s_waitcnt vmcnt(2)
  s_barrier
  ds_read_b64_tr_b16 v[32:33], v17 offset:32768
  ds_read_b64_tr_b16 v[34:35], v17 offset:33280
  buffer_load_dwordx4 v10, s[44:47], s59 offen offset:1024 lds
  v_add_f32 v113, 1.0, v113
  v_add_f32 v114, 1.0, v114
  v_add_f32 v115, 1.0, v115
  v_rcp_f32 v112, v112
  v_rcp_f32 v113, v113
  v_rcp_f32 v114, v114
  s_waitcnt lgkmcnt(2)
  v_mfma_f32_32x32x16_bf16 v[48:63], v[44:47], a[24:27], v[48:63]
  ds_read_b64_tr_b16 v[36:37], v17 offset:36864
  ds_read_b64_tr_b16 v[38:39], v17 offset:37376
  s_add_u32 m0, s88, 0
  s_nop 0
  buffer_load_dwordx4 v9, s[44:47], s60 offen lds
  v_rcp_f32 v115, v115
  v_mul_f32 v88, v112, v88
  v_mul_f32 v89, v113, v89
  v_mul_f32 v90, v114, v90
  v_mul_f32 v91, v115, v91
  v_mul_f32 v116, s75, v84
  v_mfma_f32_32x32x16_bf16 v[48:63], v[28:31], a[28:31], v[48:63]
  ds_read_b64_tr_b16 v[40:41], v17 offset:40960
  ds_read_b64_tr_b16 v[42:43], v17 offset:41472
  buffer_load_dwordx4 v10, s[44:47], s60 offen offset:1024 lds
  v_mul_f32 v117, s75, v85
  v_mul_f32 v118, s75, v86
  v_mul_f32 v119, s75, v87
  v_exp_f32 v116, v116
  v_exp_f32 v117, v117
  v_exp_f32 v118, v118
  v_exp_f32 v119, v119
  s_waitcnt lgkmcnt(2)
  v_mfma_f32_32x32x16_bf16 v[48:63], v[32:35], a[32:35], v[48:63]
  ds_read_b64_tr_b16 v[44:45], v17 offset:45056
  ds_read_b64_tr_b16 v[46:47], v17 offset:45568
  s_add_u32 m0, s89, 98304
  s_add_u32 s85, s68, s92
  buffer_load_dwordx4 v3, s[24:27], s85 offen lds
  v_mul_f32 v92, v84, v92
  v_mul_f32 v93, v85, v93
  v_mul_f32 v94, v86, v94
  v_mul_f32 v95, v87, v95
  v_add_f32 v116, 1.0, v116
  v_add_f32 v117, 1.0, v117
  v_mfma_f32_32x32x16_bf16 v[48:63], v[36:39], a[36:39], v[48:63]
  s_waitcnt vmcnt(3)
  s_barrier
  ds_read_b64_tr_b16 v[28:29], v17 offset:49152
  ds_read_b64_tr_b16 v[30:31], v17 offset:49664
  s_add_u32 m0, s89, 100352
  s_add_u32 s85, s69, s92
  buffer_load_dwordx4 v3, s[24:27], s85 offen lds
  v_add_f32 v118, 1.0, v118
  v_add_f32 v119, 1.0, v119
  v_rcp_f32 v116, v116
  v_rcp_f32 v117, v117
  v_rcp_f32 v118, v118
  v_rcp_f32 v119, v119
  s_waitcnt lgkmcnt(2)
  v_mfma_f32_32x32x16_bf16 v[48:63], v[40:43], a[40:43], v[48:63]
  ds_read_b64_tr_b16 v[32:33], v17 offset:53248
  ds_read_b64_tr_b16 v[34:35], v17 offset:53760
  s_add_u32 m0, s89, 102400
  s_add_u32 s85, s70, s92
  buffer_load_dwordx4 v3, s[24:27], s85 offen lds
  v_mul_f32 v92, v116, v92
  v_mul_f32 v93, v117, v93
  v_mul_f32 v94, v118, v94
  v_mul_f32 v95, v119, v95
  v_cvt_pk_bf16_f32 v80, v88, v89
  v_cvt_pk_bf16_f32 v81, v90, v91
  v_mfma_f32_32x32x16_bf16 v[48:63], v[44:47], a[44:47], v[48:63]
  ds_read_b64_tr_b16 v[36:37], v17 offset:57344
  ds_read_b64_tr_b16 v[38:39], v17 offset:57856
  s_add_u32 m0, s89, 104448
  s_add_u32 s85, s71, s92
  buffer_load_dwordx4 v3, s[24:27], s85 offen lds
  v_cvt_pk_bf16_f32 v82, v92, v93
  v_cvt_pk_bf16_f32 v83, v94, v95
  s_add_u32 s77, s84, s97
  s_add_u32 s77, s77, 12288
  buffer_store_dwordx4 v[80:83], v2, s[32:35], s77 offen sc1
  v_mul_f32 v112, s75, v96
  v_mul_f32 v113, s75, v97
  v_mul_f32 v114, s75, v98
  v_mul_f32 v115, s75, v99
  s_waitcnt lgkmcnt(2)
  v_mfma_f32_32x32x16_bf16 v[48:63], v[28:31], a[48:51], v[48:63]
  ds_read_b64_tr_b16 v[40:41], v17 offset:61440
  ds_read_b64_tr_b16 v[42:43], v17 offset:61952
  s_add_u32 m0, s88, 16384
  s_nop 0
  buffer_load_dwordx4 v9, s[44:47], s61 offen lds
  v_exp_f32 v112, v112
  v_exp_f32 v113, v113
  v_exp_f32 v114, v114
  v_exp_f32 v115, v115
  v_mul_f32 v104, v96, v104
  v_mul_f32 v105, v97, v105
  v_mfma_f32_32x32x16_bf16 v[48:63], v[32:35], a[52:55], v[48:63]
  s_waitcnt vmcnt(6)
  s_barrier
  ds_read_b64_tr_b16 v[44:45], v17
  ds_read_b64_tr_b16 v[46:47], v17 offset:512
  buffer_load_dwordx4 v10, s[44:47], s61 offen offset:1024 lds
  v_mul_f32 v106, v98, v106
  v_mul_f32 v107, v99, v107
  v_add_f32 v112, 1.0, v112
  v_add_f32 v113, 1.0, v113
  v_add_f32 v114, 1.0, v114
  v_add_f32 v115, 1.0, v115
  s_waitcnt lgkmcnt(2)
  v_mfma_f32_32x32x16_bf16 v[48:63], v[36:39], a[56:59], v[48:63]
  ds_read_b64_tr_b16 v[28:29], v17 offset:4096
  ds_read_b64_tr_b16 v[30:31], v17 offset:4608
  s_add_u32 m0, s88, 32768
  s_nop 0
  buffer_load_dwordx4 v9, s[44:47], s62 offen lds
  v_rcp_f32 v112, v112
  v_rcp_f32 v113, v113
  v_rcp_f32 v114, v114
  v_rcp_f32 v115, v115
  v_mul_f32 v104, v112, v104
  v_mul_f32 v105, v113, v105
  v_mfma_f32_32x32x16_bf16 v[48:63], v[40:43], a[60:63], v[48:63]
  ds_read_b64_tr_b16 v[32:33], v17 offset:8192
  ds_read_b64_tr_b16 v[34:35], v17 offset:8704
  buffer_load_dwordx4 v10, s[44:47], s62 offen offset:1024 lds
  v_mul_f32 v106, v114, v106
  v_mul_f32 v107, v115, v107
  v_mul_f32 v116, s75, v100
  v_mul_f32 v117, s75, v101
  v_mul_f32 v118, s75, v102
  v_mul_f32 v119, s75, v103
  v_exp_f32 v116, v116
  s_waitcnt lgkmcnt(2)
  v_mfma_f32_32x32x16_bf16 v[48:63], v[44:47], a[64:67], v[48:63]
  ds_read_b64_tr_b16 v[36:37], v17 offset:12288
  ds_read_b64_tr_b16 v[38:39], v17 offset:12800
  v_exp_f32 v117, v117
  v_exp_f32 v118, v118
  v_exp_f32 v119, v119
  v_mul_f32 v108, v100, v108
  v_mul_f32 v109, v101, v109
  v_mul_f32 v110, v102, v110
  s_lshr_b32 s77, s6, 1
  s_lshl_b32 s77, s77, 11
  s_lshl_b32 s78, s72, 9
  s_add_u32 s77, s77, s78
  s_add_u32 s77, s77, 11599872
  v_and_b32 v13, 3, v1
  v_lshlrev_b32 v13, 7, v13
  v_add_u32 v13, s77, v13
  v_mfma_f32_32x32x16_bf16 v[48:63], v[28:31], a[68:71], v[48:63]
  s_waitcnt vmcnt(2)
  s_barrier
  ds_read_b64_tr_b16 v[40:41], v17 offset:16384
  ds_read_b64_tr_b16 v[42:43], v17 offset:16896
  s_add_u32 m0, s88, 49152
  s_nop 0
  buffer_load_dwordx4 v9, s[44:47], s63 offen lds
  v_mul_f32 v111, v103, v111
  v_add_f32 v116, 1.0, v116
  v_add_f32 v117, 1.0, v117
  v_add_f32 v118, 1.0, v118
  v_add_f32 v119, 1.0, v119
  v_rcp_f32 v116, v116
  s_waitcnt lgkmcnt(2)
  v_mfma_f32_32x32x16_bf16 v[48:63], v[32:35], a[72:75], v[48:63]
  ds_read_b64_tr_b16 v[44:45], v17 offset:20480
  ds_read_b64_tr_b16 v[46:47], v17 offset:20992
  buffer_load_dwordx4 v10, s[44:47], s63 offen offset:1024 lds
  v_rcp_f32 v117, v117
  v_rcp_f32 v118, v118
  v_rcp_f32 v119, v119
  v_mul_f32 v108, v116, v108
  v_mul_f32 v109, v117, v109
  v_mul_f32 v110, v118, v110
  v_mfma_f32_32x32x16_bf16 v[48:63], v[36:39], a[76:79], v[48:63]
  ds_read_b64_tr_b16 v[28:29], v17 offset:24576
  ds_read_b64_tr_b16 v[30:31], v17 offset:25088
  v_mul_f32 v111, v119, v111
  v_cvt_pk_bf16_f32 v96, v104, v105
  v_cvt_pk_bf16_f32 v97, v106, v107
  v_cvt_pk_bf16_f32 v98, v108, v109
  v_cvt_pk_bf16_f32 v99, v110, v111
  s_add_u32 s77, s84, s97
  s_add_u32 s77, s77, 12288
  buffer_store_dwordx4 v[96:99], v2, s[32:35], s77 offen offset:1024 sc1
  s_waitcnt lgkmcnt(2)
  v_mfma_f32_32x32x16_bf16 v[48:63], v[40:43], a[80:83], v[48:63]
  ds_read_b64_tr_b16 v[32:33], v17 offset:28672
  ds_read_b64_tr_b16 v[34:35], v17 offset:29184
  v_mfma_f32_32x32x16_bf16 v[48:63], v[44:47], a[84:87], v[48:63]
  s_waitcnt vmcnt(3)
  s_barrier
  ds_read_b64_tr_b16 v[36:37], v17 offset:32768
  ds_read_b64_tr_b16 v[38:39], v17 offset:33280
  s_waitcnt lgkmcnt(2)
  v_mfma_f32_32x32x16_bf16 v[48:63], v[28:31], a[88:91], v[48:63]
  ds_read_b64_tr_b16 v[40:41], v17 offset:36864
  ds_read_b64_tr_b16 v[42:43], v17 offset:37376
  v_mfma_f32_32x32x16_bf16 v[48:63], v[32:35], a[92:95], v[48:63]
  ds_read_b64_tr_b16 v[44:45], v17 offset:40960
  ds_read_b64_tr_b16 v[46:47], v17 offset:41472
  s_waitcnt lgkmcnt(2)
  v_mfma_f32_32x32x16_bf16 v[48:63], v[36:39], a[96:99], v[48:63]
  ds_read_b64_tr_b16 v[28:29], v17 offset:45056
  ds_read_b64_tr_b16 v[30:31], v17 offset:45568
  v_mfma_f32_32x32x16_bf16 v[48:63], v[40:43], a[100:103], v[48:63]
  s_waitcnt vmcnt(0)
  s_barrier
  s_cmp_lg_u32 s3, 0
  s_cbranch_scc1 LD_flag1
  v_mov_b32 v24, 0
  v_mov_b32 v26, s82
  v_mov_b32 v27, s83
  s_mov_b64 exec, 1
  buffer_store_dwordx2 v[26:27], v24, s[32:35], s2 offen offset:8 sc1
  s_mov_b64 exec, -1
LD_flag1:
  s_nop 0
  ds_read_b64_tr_b16 v[32:33], v17 offset:49152
  ds_read_b64_tr_b16 v[34:35], v17 offset:49664
  s_waitcnt lgkmcnt(2)
  v_mfma_f32_32x32x16_bf16 v[48:63], v[44:47], a[104:107], v[48:63]
  ds_read_b64_tr_b16 v[36:37], v17 offset:53248
  ds_read_b64_tr_b16 v[38:39], v17 offset:53760
  v_mfma_f32_32x32x16_bf16 v[48:63], v[28:31], a[108:111], v[48:63]
  ds_read_b64_tr_b16 v[40:41], v17 offset:57344
  ds_read_b64_tr_b16 v[42:43], v17 offset:57856
  s_waitcnt lgkmcnt(2)
  v_mfma_f32_32x32x16_bf16 v[48:63], v[32:35], a[112:115], v[48:63]
  ds_read_b64_tr_b16 v[44:45], v17 offset:61440
  ds_read_b64_tr_b16 v[46:47], v17 offset:61952
  v_mfma_f32_32x32x16_bf16 v[48:63], v[36:39], a[116:119], v[48:63]
  s_waitcnt lgkmcnt(0)
  v_mfma_f32_32x32x16_bf16 v[48:63], v[40:43], a[120:123], v[48:63]
  buffer_load_dwordx2 v[122:123], v13, s[32:35], 0 offen offset:8 sc1
  v_mfma_f32_32x32x16_bf16 v[48:63], v[44:47], a[124:127], v[48:63]
  s_lshr_b32 s48, s64, 4
  s_lshr_b32 s49, s65, 4
  s_lshr_b32 s50, s66, 4
  s_lshr_b32 s51, s67, 4
  s_lshr_b32 s52, s68, 4
  s_lshr_b32 s53, s69, 4
  s_lshr_b32 s54, s70, 4
  s_lshr_b32 s55, s71, 4
  s_waitcnt lgkmcnt(0)
  s_barrier
  s_nop 1
  v_mul_f32 v112, s75, v48
  v_mul_f32 v113, s75, v49
  v_mul_f32 v114, s75, v50
  v_mul_f32 v115, s75, v51
  v_exp_f32 v112, v112
  v_exp_f32 v113, v113
  v_exp_f32 v114, v114
  v_exp_f32 v115, v115
  v_mul_f32 v56, v48, v56
  v_mul_f32 v57, v49, v57
  v_mul_f32 v58, v50, v58
  v_mul_f32 v59, v51, v59
  v_add_f32 v112, 1.0, v112
  v_add_f32 v113, 1.0, v113
  v_add_f32 v114, 1.0, v114
  v_add_f32 v115, 1.0, v115
  v_rcp_f32 v112, v112
  v_rcp_f32 v113, v113
  v_rcp_f32 v114, v114
  v_rcp_f32 v115, v115
  v_mul_f32 v56, v112, v56
  v_mul_f32 v57, v113, v57
  v_mul_f32 v58, v114, v58
  v_mul_f32 v59, v115, v59
  v_mul_f32 v116, s75, v52
  v_mul_f32 v117, s75, v53
  v_mul_f32 v118, s75, v54
  v_mul_f32 v119, s75, v55
  v_exp_f32 v116, v116
  v_exp_f32 v117, v117
  v_exp_f32 v118, v118
  v_exp_f32 v119, v119
  v_mul_f32 v60, v52, v60
  v_mul_f32 v61, v53, v61
  v_mul_f32 v62, v54, v62
  v_mul_f32 v63, v55, v63
  v_add_f32 v116, 1.0, v116
  v_add_f32 v117, 1.0, v117
  v_add_f32 v118, 1.0, v118
  v_add_f32 v119, 1.0, v119
  v_rcp_f32 v116, v116
  v_rcp_f32 v117, v117
  v_rcp_f32 v118, v118
  v_rcp_f32 v119, v119
  v_mul_f32 v60, v116, v60
  v_mul_f32 v61, v117, v61
  v_mul_f32 v62, v118, v62
  v_mul_f32 v63, v119, v63
  v_cvt_pk_bf16_f32 v48, v56, v57
  v_cvt_pk_bf16_f32 v49, v58, v59
  v_cvt_pk_bf16_f32 v50, v60, v61
  v_cvt_pk_bf16_f32 v51, v62, v63
  s_add_u32 s77, s84, s98
  s_add_u32 s77, s77, 16384
  buffer_store_dwordx4 v[48:51], v2, s[32:35], s77 offen sc1
  s_waitcnt vmcnt(1)
  v_cmp_ne_u64 vcc, s[82:83], v[122:123]
  s_mov_b32 s87, 0
  s_cmp_eq_u64 vcc, 0
  s_cbranch_scc1 LD_poll1_done
LD_poll1:
  s_sleep 1
  buffer_load_dwordx2 v[122:123], v13, s[32:35], 0 offen offset:8 sc1
  s_waitcnt vmcnt(0)
  v_cmp_ne_u64 vcc, s[82:83], v[122:123]
  s_add_u32 s87, s87, 1
  s_cmp_ge_u32 s87, 262144
  s_cbranch_scc1 LD_poll1_done
  s_cmp_eq_u64 vcc, 0
  s_cbranch_scc0 LD_poll1
LD_poll1_done:
  s_nop 0
  s_add_u32 s77, s48, s86
  buffer_load_dwordx4 a[0:3], v2, s[32:35], s77 offen sc1
  s_add_u32 s77, s49, s86
  buffer_load_dwordx4 a[4:7], v2, s[32:35], s77 offen sc1
  s_add_u32 s77, s50, s86
  buffer_load_dwordx4 a[8:11], v2, s[32:35], s77 offen sc1
  s_add_u32 s77, s51, s86
  buffer_load_dwordx4 a[12:15], v2, s[32:35], s77 offen sc1
  s_add_u32 s77, s52, s86
  buffer_load_dwordx4 a[16:19], v2, s[32:35], s77 offen sc1
  s_add_u32 s77, s53, s86
  buffer_load_dwordx4 a[20:23], v2, s[32:35], s77 offen sc1
  s_add_u32 m0, s89, 0
  s_add_u32 s85, s64, s92
  s_add_u32 s85, s85, 131072
  buffer_load_dwordx4 v3, s[24:27], s85 offen lds
  s_add_u32 m0, s89, 2048
  s_add_u32 s85, s65, s92
  s_add_u32 s85, s85, 131072
  buffer_load_dwordx4 v3, s[24:27], s85 offen lds
  s_waitcnt vmcnt(8)
  s_waitcnt lgkmcnt(0)
  s_barrier
  s_cmp_lg_u32 s3, 0
  s_cbranch_scc1 LD_flag2
  v_mov_b32 v24, 0
  v_mov_b32 v26, s82
  v_mov_b32 v27, s83
  s_mov_b64 exec, 1
  buffer_store_dwordx2 v[26:27], v24, s[32:35], s2 offen offset:16 sc1
  s_mov_b64 exec, -1
LD_flag2:
  s_nop 0
  v_and_b32 v24, 31, v1
  v_lshlrev_b32 v24, 2, v24
  s_lshl_b32 s77, s6, 8
  s_lshl_b32 s78, s73, 7
  s_add_u32 s77, s77, s78
  s_add_u32 s77, s77, 11534336
  buffer_load_dword v112, v24, s[32:35], s77 offen sc1
  ds_read_b64_tr_b16 v[28:29], v4
  ds_read_b64_tr_b16 v[30:31], v4 offset:512
  ds_read_b64_tr_b16 v[32:33], v21
  ds_read_b64_tr_b16 v[34:35], v21 offset:512
  ds_read_b64_tr_b16 v[36:37], v4 offset:2048
  ds_read_b64_tr_b16 v[38:39], v4 offset:2560
  ds_read_b64_tr_b16 v[40:41], v21 offset:2048
  ds_read_b64_tr_b16 v[42:43], v21 offset:2560
  s_waitcnt lgkmcnt(6) vmcnt(8)
  v_mfma_f32_32x32x16_bf16 v[80:95], v[28:31], a[0:3], 0
  ds_read_b64_tr_b16 v[120:121], v4 offset:4096
  ds_read_b64_tr_b16 v[122:123], v4 offset:4608
  ds_read_b64_tr_b16 v[124:125], v21 offset:4096
  ds_read_b64_tr_b16 v[126:127], v21 offset:4608
  s_add_u32 m0, s89, 4096
  s_add_u32 s85, s66, s92
  s_add_u32 s85, s85, 131072
  buffer_load_dwordx4 v3, s[24:27], s85 offen lds
  s_add_u32 m0, s89, 6144
  s_add_u32 s85, s67, s92
  s_add_u32 s85, s85, 131072
  buffer_load_dwordx4 v3, s[24:27], s85 offen lds
  s_waitcnt lgkmcnt(8)
  v_mfma_f32_32x32x16_bf16 v[96:111], v[32:35], a[0:3], 0
  s_add_u32 m0, s89, 32768
  s_add_u32 s85, s68, s92
  s_add_u32 s85, s85, 131072
  buffer_load_dwordx4 v3, s[24:27], s85 offen lds
  s_add_u32 m0, s89, 34816
  s_add_u32 s85, s69, s92
  s_add_u32 s85, s85, 131072
  buffer_load_dwordx4 v3, s[24:27], s85 offen lds
  s_waitcnt lgkmcnt(6) vmcnt(11)
  v_mfma_f32_32x32x16_bf16 v[80:95], v[36:39], a[4:7], v[80:95]
  ds_read_b64_tr_b16 v[28:29], v4 offset:6144
  ds_read_b64_tr_b16 v[30:31], v4 offset:6656
  ds_read_b64_tr_b16 v[32:33], v21 offset:6144
  ds_read_b64_tr_b16 v[34:35], v21 offset:6656
  s_add_u32 m0, s89, 36864
  s_add_u32 s85, s70, s92
  s_add_u32 s85, s85, 131072
  buffer_load_dwordx4 v3, s[24:27], s85 offen lds
  s_add_u32 m0, s89, 38912
  s_add_u32 s85, s71, s92
  s_add_u32 s85, s85, 131072
  buffer_load_dwordx4 v3, s[24:27], s85 offen lds
  s_waitcnt lgkmcnt(8)
  v_mfma_f32_32x32x16_bf16 v[96:111], v[40:43], a[4:7], v[96:111]
  s_add_u32 s77, s54, s86
  buffer_load_dwordx4 a[24:27], v2, s[32:35], s77 offen sc1
  s_add_u32 s77, s55, s86
  buffer_load_dwordx4 a[28:31], v2, s[32:35], s77 offen sc1
  s_waitcnt lgkmcnt(6) vmcnt(14)
  v_mfma_f32_32x32x16_bf16 v[80:95], v[120:123], a[8:11], v[80:95]
  s_barrier
  ds_read_b64_tr_b16 v[36:37], v7 offset:32768
  ds_read_b64_tr_b16 v[38:39], v7 offset:33280
  ds_read_b64_tr_b16 v[40:41], v8 offset:32768
  ds_read_b64_tr_b16 v[42:43], v8 offset:33280
  s_add_u32 s77, s48, s86
  s_add_u32 s77, s77, 8192
  buffer_load_dwordx4 a[32:35], v2, s[32:35], s77 offen sc1
  s_add_u32 s77, s49, s86
  s_add_u32 s77, s77, 8192
  buffer_load_dwordx4 a[36:39], v2, s[32:35], s77 offen sc1
  s_waitcnt lgkmcnt(8)
  v_mfma_f32_32x32x16_bf16 v[96:111], v[124:127], a[8:11], v[96:111]
  s_add_u32 s77, s50, s86
  s_add_u32 s77, s77, 8192
  buffer_load_dwordx4 a[40:43], v2, s[32:35], s77 offen sc1
  s_add_u32 s77, s51, s86
  s_add_u32 s77, s77, 8192
  buffer_load_dwordx4 a[44:47], v2, s[32:35], s77 offen sc1
  s_waitcnt lgkmcnt(6) vmcnt(17)
  v_mfma_f32_32x32x16_bf16 v[80:95], v[28:31], a[12:15], v[80:95]
  ds_read_b64_tr_b16 v[120:121], v7 offset:34816
  ds_read_b64_tr_b16 v[122:123], v7 offset:35328
  ds_read_b64_tr_b16 v[124:125], v8 offset:34816
  ds_read_b64_tr_b16 v[126:127], v8 offset:35328
  s_add_u32 s77, s52, s86
  s_add_u32 s77, s77, 8192
  buffer_load_dwordx4 a[48:51], v2, s[32:35], s77 offen sc1
  s_add_u32 s77, s53, s86
  s_add_u32 s77, s77, 8192
  buffer_load_dwordx4 a[52:55], v2, s[32:35], s77 offen sc1
  s_waitcnt lgkmcnt(8)
  v_mfma_f32_32x32x16_bf16 v[96:111], v[32:35], a[12:15], v[96:111]
  s_add_u32 s77, s54, s86
  s_add_u32 s77, s77, 8192
  buffer_load_dwordx4 a[56:59], v2, s[32:35], s77 offen sc1
  s_add_u32 s77, s55, s86
  s_add_u32 s77, s77, 8192
  buffer_load_dwordx4 a[60:63], v2, s[32:35], s77 offen sc1
  s_waitcnt lgkmcnt(6) vmcnt(20)
  v_mfma_f32_32x32x16_bf16 v[80:95], v[36:39], a[16:19], v[80:95]
  ds_read_b64_tr_b16 v[28:29], v7 offset:36864
  ds_read_b64_tr_b16 v[30:31], v7 offset:37376
  ds_read_b64_tr_b16 v[32:33], v8 offset:36864
  ds_read_b64_tr_b16 v[34:35], v8 offset:37376
  s_add_u32 s77, s48, s86
  s_add_u32 s77, s77, 20480
  buffer_load_dwordx4 a[64:67], v2, s[32:35], s77 offen sc1
  s_add_u32 s77, s49, s86
  s_add_u32 s77, s77, 20480
  buffer_load_dwordx4 a[68:71], v2, s[32:35], s77 offen sc1
  s_waitcnt lgkmcnt(8)
  v_mfma_f32_32x32x16_bf16 v[96:111], v[40:43], a[16:19], v[96:111]
  s_add_u32 s77, s50, s86
  s_add_u32 s77, s77, 20480
  buffer_load_dwordx4 a[72:75], v2, s[32:35], s77 offen sc1
  s_add_u32 s77, s51, s86
  s_add_u32 s77, s77, 20480
  buffer_load_dwordx4 a[76:79], v2, s[32:35], s77 offen sc1
  s_waitcnt lgkmcnt(6) vmcnt(23)
  v_mfma_f32_32x32x16_bf16 v[80:95], v[120:123], a[20:23], v[80:95]
  ds_read_b64_tr_b16 v[36:37], v7 offset:38912
  ds_read_b64_tr_b16 v[38:39], v7 offset:39424
  ds_read_b64_tr_b16 v[40:41], v8 offset:38912
  ds_read_b64_tr_b16 v[42:43], v8 offset:39424
  s_add_u32 s77, s52, s86
  s_add_u32 s77, s77, 20480
  buffer_load_dwordx4 a[80:83], v2, s[32:35], s77 offen sc1
  s_add_u32 s77, s53, s86
  s_add_u32 s77, s77, 20480
  buffer_load_dwordx4 a[84:87], v2, s[32:35], s77 offen sc1
  s_waitcnt lgkmcnt(8)
  v_mfma_f32_32x32x16_bf16 v[96:111], v[124:127], a[20:23], v[96:111]
  s_add_u32 s77, s54, s86
  s_add_u32 s77, s77, 20480
  buffer_load_dwordx4 a[88:91], v2, s[32:35], s77 offen sc1
  s_add_u32 s77, s55, s86
  s_add_u32 s77, s77, 20480
  buffer_load_dwordx4 a[92:95], v2, s[32:35], s77 offen sc1
  s_waitcnt lgkmcnt(6) vmcnt(17)
  v_mfma_f32_32x32x16_bf16 v[80:95], v[28:31], a[24:27], v[80:95]
  s_barrier
  ds_read_b64_tr_b16 v[120:121], v5
  ds_read_b64_tr_b16 v[122:123], v5 offset:512
  ds_read_b64_tr_b16 v[124:125], v6
  ds_read_b64_tr_b16 v[126:127], v6 offset:512
  s_add_u32 m0, s89, 65536
  s_add_u32 s85, s64, s92
  s_add_u32 s85, s85, 327680
  buffer_load_dwordx4 v3, s[24:27], s85 offen lds
  s_add_u32 m0, s89, 67584
  s_add_u32 s85, s65, s92
  s_add_u32 s85, s85, 327680
  buffer_load_dwordx4 v3, s[24:27], s85 offen lds
  s_waitcnt lgkmcnt(8)
  v_mfma_f32_32x32x16_bf16 v[96:111], v[32:35], a[24:27], v[96:111]
  s_add_u32 m0, s89, 69632
  s_add_u32 s85, s66, s92
  s_add_u32 s85, s85, 327680
  buffer_load_dwordx4 v3, s[24:27], s85 offen lds
  s_add_u32 m0, s89, 71680
  s_add_u32 s85, s67, s92
  s_add_u32 s85, s85, 327680
  buffer_load_dwordx4 v3, s[24:27], s85 offen lds
  s_waitcnt lgkmcnt(6) vmcnt(20)
  v_mfma_f32_32x32x16_bf16 v[80:95], v[36:39], a[28:31], v[80:95]
  ds_read_b64_tr_b16 v[28:29], v5 offset:2048
  ds_read_b64_tr_b16 v[30:31], v5 offset:2560
  ds_read_b64_tr_b16 v[32:33], v6 offset:2048
  ds_read_b64_tr_b16 v[34:35], v6 offset:2560
  s_add_u32 m0, s89, 131072
  s_add_u32 s85, s68, s92
  s_add_u32 s85, s85, 327680
  buffer_load_dwordx4 v3, s[24:27], s85 offen lds
  s_add_u32 m0, s89, 133120
  s_add_u32 s85, s69, s92
  s_add_u32 s85, s85, 327680
  buffer_load_dwordx4 v3, s[24:27], s85 offen lds
  s_waitcnt lgkmcnt(8)
  v_mfma_f32_32x32x16_bf16 v[96:111], v[40:43], a[28:31], v[96:111]
  s_add_u32 m0, s89, 135168
  s_add_u32 s85, s70, s92
  s_add_u32 s85, s85, 327680
  buffer_load_dwordx4 v3, s[24:27], s85 offen lds
  s_add_u32 m0, s89, 137216
  s_add_u32 s85, s71, s92
  s_add_u32 s85, s85, 327680
  buffer_load_dwordx4 v3, s[24:27], s85 offen lds
  s_waitcnt lgkmcnt(6) vmcnt(23)
  v_mfma_f32_32x32x16_bf16 v[80:95], v[120:123], a[32:35], v[80:95]
  ds_read_b64_tr_b16 v[36:37], v5 offset:4096
  ds_read_b64_tr_b16 v[38:39], v5 offset:4608
  ds_read_b64_tr_b16 v[40:41], v6 offset:4096
  ds_read_b64_tr_b16 v[42:43], v6 offset:4608
  s_waitcnt lgkmcnt(8)
  v_mfma_f32_32x32x16_bf16 v[96:111], v[124:127], a[32:35], v[96:111]
  s_waitcnt lgkmcnt(6) vmcnt(22)
  v_mfma_f32_32x32x16_bf16 v[80:95], v[28:31], a[36:39], v[80:95]
  ds_read_b64_tr_b16 v[120:121], v5 offset:6144
  ds_read_b64_tr_b16 v[122:123], v5 offset:6656
  ds_read_b64_tr_b16 v[124:125], v6 offset:6144
  ds_read_b64_tr_b16 v[126:127], v6 offset:6656
  s_waitcnt lgkmcnt(8)
  v_mfma_f32_32x32x16_bf16 v[96:111], v[32:35], a[36:39], v[96:111]
  s_waitcnt lgkmcnt(6) vmcnt(21)
  v_mfma_f32_32x32x16_bf16 v[80:95], v[36:39], a[40:43], v[80:95]
  s_barrier
  ds_read_b64_tr_b16 v[28:29], v5 offset:32768
  ds_read_b64_tr_b16 v[30:31], v5 offset:33280
  ds_read_b64_tr_b16 v[32:33], v6 offset:32768
  ds_read_b64_tr_b16 v[34:35], v6 offset:33280
  s_add_u32 m0, s89, 98304
  s_add_u32 s85, s64, s93
  buffer_load_dwordx4 v3, s[28:31], s85 offen lds
  s_add_u32 m0, s89, 100352
  s_add_u32 s85, s65, s93
  buffer_load_dwordx4 v3, s[28:31], s85 offen lds
  s_waitcnt lgkmcnt(8)
  v_mfma_f32_32x32x16_bf16 v[96:111], v[40:43], a[40:43], v[96:111]
  s_add_u32 m0, s89, 102400
  s_add_u32 s85, s66, s93
  buffer_load_dwordx4 v3, s[28:31], s85 offen lds
  s_add_u32 m0, s89, 104448
  s_add_u32 s85, s67, s93
  buffer_load_dwordx4 v3, s[28:31], s85 offen lds
  s_waitcnt lgkmcnt(6) vmcnt(24)
  v_mfma_f32_32x32x16_bf16 v[80:95], v[120:123], a[44:47], v[80:95]
  ds_read_b64_tr_b16 v[36:37], v5 offset:34816
  ds_read_b64_tr_b16 v[38:39], v5 offset:35328
  ds_read_b64_tr_b16 v[40:41], v6 offset:34816
  ds_read_b64_tr_b16 v[42:43], v6 offset:35328
  s_waitcnt lgkmcnt(8)
  v_mfma_f32_32x32x16_bf16 v[96:111], v[124:127], a[44:47], v[96:111]
  s_waitcnt lgkmcnt(6) vmcnt(23)
  v_mfma_f32_32x32x16_bf16 v[80:95], v[28:31], a[48:51], v[80:95]
  ds_read_b64_tr_b16 v[120:121], v5 offset:36864
  ds_read_b64_tr_b16 v[122:123], v5 offset:37376
  ds_read_b64_tr_b16 v[124:125], v6 offset:36864
  ds_read_b64_tr_b16 v[126:127], v6 offset:37376
  s_waitcnt lgkmcnt(8)
  v_mfma_f32_32x32x16_bf16 v[96:111], v[32:35], a[48:51], v[96:111]
  s_waitcnt lgkmcnt(6) vmcnt(22)
  v_mfma_f32_32x32x16_bf16 v[80:95], v[36:39], a[52:55], v[80:95]
  ds_read_b64_tr_b16 v[28:29], v5 offset:38912
  ds_read_b64_tr_b16 v[30:31], v5 offset:39424
  ds_read_b64_tr_b16 v[32:33], v6 offset:38912
  ds_read_b64_tr_b16 v[34:35], v6 offset:39424
  s_waitcnt lgkmcnt(8)
  v_mfma_f32_32x32x16_bf16 v[96:111], v[40:43], a[52:55], v[96:111]
  s_waitcnt lgkmcnt(6) vmcnt(21)
  v_mfma_f32_32x32x16_bf16 v[80:95], v[120:123], a[56:59], v[80:95]
  s_waitcnt vmcnt(8)
  s_barrier
  ds_read_b64_tr_b16 v[36:37], v7
  ds_read_b64_tr_b16 v[38:39], v7 offset:512
  ds_read_b64_tr_b16 v[40:41], v8
  ds_read_b64_tr_b16 v[42:43], v8 offset:512
  s_add_u32 m0, s89, 0
  s_add_u32 s85, s68, s93
  buffer_load_dwordx4 v3, s[28:31], s85 offen lds
  s_add_u32 m0, s89, 2048
  s_add_u32 s85, s69, s93
  buffer_load_dwordx4 v3, s[28:31], s85 offen lds
  s_waitcnt lgkmcnt(8)
  v_mfma_f32_32x32x16_bf16 v[96:111], v[124:127], a[56:59], v[96:111]
  s_add_u32 m0, s89, 4096
  s_add_u32 s85, s70, s93
  buffer_load_dwordx4 v3, s[28:31], s85 offen lds
  s_add_u32 m0, s89, 6144
  s_add_u32 s85, s71, s93
  buffer_load_dwordx4 v3, s[28:31], s85 offen lds
  buffer_load_dwordx2 v[46:47], v13, s[32:35], 0 offen offset:16 sc1
  s_waitcnt lgkmcnt(6)
  v_mfma_f32_32x32x16_bf16 v[80:95], v[28:31], a[60:63], v[80:95]
  ds_read_b64_tr_b16 v[120:121], v7 offset:2048
  ds_read_b64_tr_b16 v[122:123], v7 offset:2560
  ds_read_b64_tr_b16 v[124:125], v8 offset:2048
  ds_read_b64_tr_b16 v[126:127], v8 offset:2560
  s_waitcnt lgkmcnt(8)
  v_mfma_f32_32x32x16_bf16 v[96:111], v[32:35], a[60:63], v[96:111]
  s_waitcnt lgkmcnt(6)
  v_mfma_f32_32x32x16_bf16 v[80:95], v[36:39], a[64:67], v[80:95]
  ds_read_b64_tr_b16 v[28:29], v7 offset:4096
  ds_read_b64_tr_b16 v[30:31], v7 offset:4608
  ds_read_b64_tr_b16 v[32:33], v8 offset:4096
  ds_read_b64_tr_b16 v[34:35], v8 offset:4608
  s_waitcnt lgkmcnt(8)
  v_mfma_f32_32x32x16_bf16 v[96:111], v[40:43], a[64:67], v[96:111]
  s_waitcnt lgkmcnt(6)
  v_mfma_f32_32x32x16_bf16 v[80:95], v[120:123], a[68:71], v[80:95]
  ds_read_b64_tr_b16 v[36:37], v7 offset:6144
  ds_read_b64_tr_b16 v[38:39], v7 offset:6656
  ds_read_b64_tr_b16 v[40:41], v8 offset:6144
  ds_read_b64_tr_b16 v[42:43], v8 offset:6656
  s_waitcnt lgkmcnt(8)
  v_mfma_f32_32x32x16_bf16 v[96:111], v[124:127], a[68:71], v[96:111]
  s_waitcnt lgkmcnt(6)
  v_mfma_f32_32x32x16_bf16 v[80:95], v[28:31], a[72:75], v[80:95]
  s_waitcnt vmcnt(9)
  s_barrier
  ds_read_b64_tr_b16 v[120:121], v4
  ds_read_b64_tr_b16 v[122:123], v4 offset:512
  ds_read_b64_tr_b16 v[124:125], v21
  ds_read_b64_tr_b16 v[126:127], v21 offset:512
  s_add_u32 m0, s89, 32768
  s_and_b32 s85, s64, 49152
  s_add_u32 s85, s85, s92
  s_add_u32 s85, s85, 262144
  buffer_load_dwordx4 v3, s[24:27], s85 offen lds
  s_add_u32 m0, s89, 34816
  s_and_b32 s85, s65, 49152
  s_add_u32 s85, s85, s92
  s_add_u32 s85, s85, 262144
  buffer_load_dwordx4 v3, s[24:27], s85 offen lds
  s_waitcnt lgkmcnt(8)
  v_mfma_f32_32x32x16_bf16 v[96:111], v[32:35], a[72:75], v[96:111]
  s_add_u32 m0, s89, 36864
  s_and_b32 s85, s66, 49152
  s_add_u32 s85, s85, s92
  s_add_u32 s85, s85, 262144
  buffer_load_dwordx4 v3, s[24:27], s85 offen lds
  s_add_u32 m0, s89, 38912
  s_and_b32 s85, s67, 49152
  s_add_u32 s85, s85, s92
  s_add_u32 s85, s85, 262144
  buffer_load_dwordx4 v3, s[24:27], s85 offen lds
  s_waitcnt lgkmcnt(6)
  v_mfma_f32_32x32x16_bf16 v[80:95], v[36:39], a[76:79], v[80:95]
  ds_read_b64_tr_b16 v[28:29], v4 offset:2048
  ds_read_b64_tr_b16 v[30:31], v4 offset:2560
  ds_read_b64_tr_b16 v[32:33], v21 offset:2048
  ds_read_b64_tr_b16 v[34:35], v21 offset:2560
  s_waitcnt vmcnt(4)
  v_cmp_ne_u64 vcc, s[82:83], v[46:47]
  s_mov_b32 s87, 0
  s_cmp_eq_u64 vcc, 0
  s_cbranch_scc1 LD_poll2_done
LD_poll2:
  s_sleep 1
  buffer_load_dwordx2 v[46:47], v13, s[32:35], 0 offen offset:16 sc1
  s_waitcnt vmcnt(0)
  v_cmp_ne_u64 vcc, s[82:83], v[46:47]
  s_add_u32 s87, s87, 1
  s_cmp_ge_u32 s87, 262144
  s_cbranch_scc1 LD_poll2_done
  s_cmp_eq_u64 vcc, 0
  s_cbranch_scc0 LD_poll2
LD_poll2_done:
  s_nop 0
  s_add_u32 s77, s48, s86
  s_add_u32 s77, s77, 28672
  buffer_load_dwordx4 a[96:99], v2, s[32:35], s77 offen sc1
  s_waitcnt lgkmcnt(8)
  v_mfma_f32_32x32x16_bf16 v[96:111], v[40:43], a[76:79], v[96:111]
  s_add_u32 s77, s49, s86
  s_add_u32 s77, s77, 28672
  buffer_load_dwordx4 a[100:103], v2, s[32:35], s77 offen sc1
  s_add_u32 s77, s50, s86
  s_add_u32 s77, s77, 28672
  buffer_load_dwordx4 a[104:107], v2, s[32:35], s77 offen sc1
  s_waitcnt lgkmcnt(6)
  v_mfma_f32_32x32x16_bf16 v[80:95], v[120:123], a[80:83], v[80:95]
  ds_read_b64_tr_b16 v[36:37], v4 offset:4096
  ds_read_b64_tr_b16 v[38:39], v4 offset:4608
  ds_read_b64_tr_b16 v[40:41], v21 offset:4096
  ds_read_b64_tr_b16 v[42:43], v21 offset:4608
  s_add_u32 s77, s51, s86
  s_add_u32 s77, s77, 28672
  buffer_load_dwordx4 a[108:111], v2, s[32:35], s77 offen sc1
  s_add_u32 s77, s52, s86
  s_add_u32 s77, s77, 28672
  buffer_load_dwordx4 a[112:115], v2, s[32:35], s77 offen sc1
  s_waitcnt lgkmcnt(8)
  v_mfma_f32_32x32x16_bf16 v[96:111], v[124:127], a[80:83], v[96:111]
  s_add_u32 s77, s53, s86
  s_add_u32 s77, s77, 28672
  buffer_load_dwordx4 a[116:119], v2, s[32:35], s77 offen sc1
  s_add_u32 s77, s54, s86
  s_add_u32 s77, s77, 28672
  buffer_load_dwordx4 a[120:123], v2, s[32:35], s77 offen sc1
  s_waitcnt lgkmcnt(6)
  v_mfma_f32_32x32x16_bf16 v[80:95], v[28:31], a[84:87], v[80:95]
  ds_read_b64_tr_b16 v[120:121], v4 offset:6144
  ds_read_b64_tr_b16 v[122:123], v4 offset:6656
  ds_read_b64_tr_b16 v[124:125], v21 offset:6144
  ds_read_b64_tr_b16 v[126:127], v21 offset:6656
  s_add_u32 s77, s55, s86
  s_add_u32 s77, s77, 28672
  buffer_load_dwordx4 a[124:127], v2, s[32:35], s77 offen sc1
  s_and_b32 s77, s48, 3072
  s_add_u32 s77, s77, s86
  s_add_u32 s77, s77, 16384
  buffer_load_dwordx4 a[0:3], v2, s[32:35], s77 offen sc1
  s_waitcnt lgkmcnt(8)
  v_mfma_f32_32x32x16_bf16 v[96:111], v[32:35], a[84:87], v[96:111]
  s_and_b32 s77, s49, 3072
  s_add_u32 s77, s77, s86
  s_add_u32 s77, s77, 16384
  buffer_load_dwordx4 a[4:7], v2, s[32:35], s77 offen sc1
  s_and_b32 s77, s50, 3072
  s_add_u32 s77, s77, s86
  s_add_u32 s77, s77, 16384
  buffer_load_dwordx4 a[8:11], v2, s[32:35], s77 offen sc1
  s_waitcnt lgkmcnt(6)
  v_mfma_f32_32x32x16_bf16 v[80:95], v[36:39], a[88:91], v[80:95]
  s_barrier
  ds_read_b64_tr_b16 v[28:29], v7 offset:32768
  ds_read_b64_tr_b16 v[30:31], v7 offset:33280
  ds_read_b64_tr_b16 v[32:33], v8 offset:32768
  ds_read_b64_tr_b16 v[34:35], v8 offset:33280
  s_and_b32 s77, s51, 3072
  s_add_u32 s77, s77, s86
  s_add_u32 s77, s77, 16384
  buffer_load_dwordx4 a[12:15], v2, s[32:35], s77 offen sc1
  s_waitcnt lgkmcnt(8)
  v_mfma_f32_32x32x16_bf16 v[96:111], v[40:43], a[88:91], v[96:111]
  s_waitcnt lgkmcnt(6)
  v_mfma_f32_32x32x16_bf16 v[80:95], v[120:123], a[92:95], v[80:95]
  ds_read_b64_tr_b16 v[36:37], v7 offset:34816
  ds_read_b64_tr_b16 v[38:39], v7 offset:35328
  ds_read_b64_tr_b16 v[40:41], v8 offset:34816
  ds_read_b64_tr_b16 v[42:43], v8 offset:35328
  s_waitcnt lgkmcnt(8)
  v_mfma_f32_32x32x16_bf16 v[96:111], v[124:127], a[92:95], v[96:111]
  s_waitcnt lgkmcnt(6) vmcnt(11)
  v_mfma_f32_32x32x16_bf16 v[48:63], v[28:31], a[96:99], 0
  ds_read_b64_tr_b16 v[120:121], v7 offset:36864
  ds_read_b64_tr_b16 v[122:123], v7 offset:37376
  ds_read_b64_tr_b16 v[124:125], v8 offset:36864
  ds_read_b64_tr_b16 v[126:127], v8 offset:37376
  s_waitcnt lgkmcnt(8)
  v_mfma_f32_32x32x16_bf16 v[64:79], v[32:35], a[96:99], 0
  s_waitcnt lgkmcnt(6) vmcnt(10)
  v_mfma_f32_32x32x16_bf16 v[48:63], v[36:39], a[100:103], v[48:63]
  ds_read_b64_tr_b16 v[28:29], v7 offset:38912
  ds_read_b64_tr_b16 v[30:31], v7 offset:39424
  ds_read_b64_tr_b16 v[32:33], v8 offset:38912
  ds_read_b64_tr_b16 v[34:35], v8 offset:39424
  s_waitcnt lgkmcnt(8)
  v_mfma_f32_32x32x16_bf16 v[64:79], v[40:43], a[100:103], v[64:79]
  s_waitcnt lgkmcnt(6) vmcnt(9)
  v_mfma_f32_32x32x16_bf16 v[48:63], v[120:123], a[104:107], v[48:63]
  s_barrier
  ds_read_b64_tr_b16 v[36:37], v5
  ds_read_b64_tr_b16 v[38:39], v5 offset:512
  ds_read_b64_tr_b16 v[40:41], v6
  ds_read_b64_tr_b16 v[42:43], v6 offset:512
  s_waitcnt lgkmcnt(8)
  v_mfma_f32_32x32x16_bf16 v[64:79], v[124:127], a[104:107], v[64:79]
  s_waitcnt lgkmcnt(6) vmcnt(8)
  v_mfma_f32_32x32x16_bf16 v[48:63], v[28:31], a[108:111], v[48:63]
  ds_read_b64_tr_b16 v[120:121], v5 offset:2048
  ds_read_b64_tr_b16 v[122:123], v5 offset:2560
  ds_read_b64_tr_b16 v[124:125], v6 offset:2048
  ds_read_b64_tr_b16 v[126:127], v6 offset:2560
  s_waitcnt lgkmcnt(8)
  v_mfma_f32_32x32x16_bf16 v[64:79], v[32:35], a[108:111], v[64:79]
  s_waitcnt lgkmcnt(6) vmcnt(7)
  v_mfma_f32_32x32x16_bf16 v[48:63], v[36:39], a[112:115], v[48:63]
  ds_read_b64_tr_b16 v[28:29], v5 offset:4096
  ds_read_b64_tr_b16 v[30:31], v5 offset:4608
  ds_read_b64_tr_b16 v[32:33], v6 offset:4096
  ds_read_b64_tr_b16 v[34:35], v6 offset:4608
  s_waitcnt lgkmcnt(8)
  v_mfma_f32_32x32x16_bf16 v[64:79], v[40:43], a[112:115], v[64:79]
  s_waitcnt lgkmcnt(6) vmcnt(6)
  v_mfma_f32_32x32x16_bf16 v[48:63], v[120:123], a[116:119], v[48:63]
  ds_read_b64_tr_b16 v[36:37], v5 offset:6144
  ds_read_b64_tr_b16 v[38:39], v5 offset:6656
  ds_read_b64_tr_b16 v[40:41], v6 offset:6144
  ds_read_b64_tr_b16 v[42:43], v6 offset:6656
  s_waitcnt lgkmcnt(8)
  v_mfma_f32_32x32x16_bf16 v[64:79], v[124:127], a[116:119], v[64:79]
  s_waitcnt lgkmcnt(6) vmcnt(5)
  v_mfma_f32_32x32x16_bf16 v[48:63], v[28:31], a[120:123], v[48:63]
  s_barrier
  ds_read_b64_tr_b16 v[120:121], v5 offset:32768
  ds_read_b64_tr_b16 v[122:123], v5 offset:33280
  ds_read_b64_tr_b16 v[124:125], v6 offset:32768
  ds_read_b64_tr_b16 v[126:127], v6 offset:33280
  s_waitcnt lgkmcnt(8)
  v_mfma_f32_32x32x16_bf16 v[64:79], v[32:35], a[120:123], v[64:79]
  s_waitcnt lgkmcnt(6) vmcnt(4)
  v_mfma_f32_32x32x16_bf16 v[48:63], v[36:39], a[124:127], v[48:63]
  ds_read_b64_tr_b16 v[28:29], v5 offset:34816
  ds_read_b64_tr_b16 v[30:31], v5 offset:35328
  ds_read_b64_tr_b16 v[32:33], v6 offset:34816
  ds_read_b64_tr_b16 v[34:35], v6 offset:35328
  s_waitcnt lgkmcnt(8)
  v_mfma_f32_32x32x16_bf16 v[64:79], v[40:43], a[124:127], v[64:79]
  s_waitcnt lgkmcnt(6) vmcnt(3)
  v_mfma_f32_32x32x16_bf16 v[80:95], v[120:123], a[0:3], v[80:95]
  ds_read_b64_tr_b16 v[36:37], v5 offset:36864
  ds_read_b64_tr_b16 v[38:39], v5 offset:37376
  ds_read_b64_tr_b16 v[40:41], v6 offset:36864
  ds_read_b64_tr_b16 v[42:43], v6 offset:37376
  s_waitcnt lgkmcnt(8)
  v_mfma_f32_32x32x16_bf16 v[96:111], v[124:127], a[0:3], v[96:111]
  s_waitcnt lgkmcnt(6) vmcnt(2)
  v_mfma_f32_32x32x16_bf16 v[80:95], v[28:31], a[4:7], v[80:95]
  ds_read_b64_tr_b16 v[120:121], v5 offset:38912
  ds_read_b64_tr_b16 v[122:123], v5 offset:39424
  ds_read_b64_tr_b16 v[124:125], v6 offset:38912
  ds_read_b64_tr_b16 v[126:127], v6 offset:39424
  s_waitcnt lgkmcnt(8)
  v_mfma_f32_32x32x16_bf16 v[96:111], v[32:35], a[4:7], v[96:111]
  v_sub_f32 v113, 1.0, v112
  v_mul_f32 v48, v112, v48
  v_mul_f32 v49, v112, v49
  v_mul_f32 v50, v112, v50
  v_mul_f32 v51, v112, v51
  v_mul_f32 v52, v112, v52
  v_mul_f32 v53, v112, v53
  v_mul_f32 v54, v112, v54
  v_mul_f32 v55, v112, v55
  v_mul_f32 v56, v112, v56
  v_mul_f32 v57, v112, v57
  v_mul_f32 v58, v112, v58
  v_mul_f32 v59, v112, v59
  v_mul_f32 v60, v112, v60
  v_mul_f32 v61, v112, v61
  v_mul_f32 v62, v112, v62
  v_mul_f32 v63, v112, v63
  v_mul_f32 v64, v112, v64
  v_mul_f32 v65, v112, v65
  v_mul_f32 v66, v112, v66
  v_mul_f32 v67, v112, v67
  v_mul_f32 v68, v112, v68
  v_mul_f32 v69, v112, v69
  v_mul_f32 v70, v112, v70
  v_mul_f32 v71, v112, v71
  v_mul_f32 v72, v112, v72
  v_mul_f32 v73, v112, v73
  v_mul_f32 v74, v112, v74
  v_mul_f32 v75, v112, v75
  v_mul_f32 v76, v112, v76
  v_mul_f32 v77, v112, v77
  v_mul_f32 v78, v112, v78
  v_mul_f32 v79, v112, v79
  s_waitcnt lgkmcnt(6) vmcnt(1)
  v_mfma_f32_32x32x16_bf16 v[80:95], v[36:39], a[8:11], v[80:95]
  s_waitcnt lgkmcnt(4)
  v_mfma_f32_32x32x16_bf16 v[96:111], v[40:43], a[8:11], v[96:111]
  s_waitcnt lgkmcnt(2) vmcnt(0)
  v_mfma_f32_32x32x16_bf16 v[80:95], v[120:123], a[12:15], v[80:95]
  s_waitcnt lgkmcnt(0)
  v_mfma_f32_32x32x16_bf16 v[96:111], v[124:127], a[12:15], v[96:111]
  v_and_b32 v24, 31, v1
  v_mul_u32_u24 v24, 272, v24
  v_lshrrev_b32 v25, 5, v1
  v_lshl_add_u32 v24, v25, 4, v24
  s_mul_i32 s77, s72, 17408
  s_mul_i32 s78, s73, 8704
  s_add_u32 s77, s77, s78
  s_add_u32 s77, s77, 65536
  v_add_u32 v114, s77, v24
  s_nop 0
  v_fmac_f32 v48, v113, v80
  v_fmac_f32 v49, v113, v81
  v_fmac_f32 v50, v113, v82
  v_fmac_f32 v51, v113, v83
  ds_write_b128 v114, v[48:51]
  v_fmac_f32 v52, v113, v84
  v_fmac_f32 v53, v113, v85
  v_fmac_f32 v54, v113, v86
  v_fmac_f32 v55, v113, v87
  ds_write_b128 v114, v[52:55] offset:32
  v_fmac_f32 v56, v113, v88
  v_fmac_f32 v57, v113, v89
  v_fmac_f32 v58, v113, v90
  v_fmac_f32 v59, v113, v91
  ds_write_b128 v114, v[56:59] offset:64
  v_fmac_f32 v60, v113, v92
  v_fmac_f32 v61, v113, v93
  v_fmac_f32 v62, v113, v94
  v_fmac_f32 v63, v113, v95
  ds_write_b128 v114, v[60:63] offset:96
  v_fmac_f32 v64, v113, v96
  v_fmac_f32 v65, v113, v97
  v_fmac_f32 v66, v113, v98
  v_fmac_f32 v67, v113, v99
  ds_write_b128 v114, v[64:67] offset:128
  v_fmac_f32 v68, v113, v100
  v_fmac_f32 v69, v113, v101
  v_fmac_f32 v70, v113, v102
  v_fmac_f32 v71, v113, v103
  ds_write_b128 v114, v[68:71] offset:160
  v_fmac_f32 v72, v113, v104
  v_fmac_f32 v73, v113, v105
  v_fmac_f32 v74, v113, v106
  v_fmac_f32 v75, v113, v107
  ds_write_b128 v114, v[72:75] offset:192
  v_fmac_f32 v76, v113, v108
  v_fmac_f32 v77, v113, v109
  v_fmac_f32 v78, v113, v110
  v_fmac_f32 v79, v113, v111
  ds_write_b128 v114, v[76:79] offset:224
  v_lshrrev_b32 v24, 3, v1
  s_lshl_b32 s77, s3, 3
  v_add_u32 v24, s77, v24
  v_mul_u32_u24 v25, 272, v24
  v_and_b32 v26, 7, v1
  v_lshl_add_u32 v115, v26, 5, v25
  v_add_u32 v115, 65536, v115
  v_lshlrev_b32 v24, 10, v24
  v_lshl_add_u32 v24, v26, 4, v24
  s_lshl_b32 s77, s6, 16
  s_lshl_b32 s78, s7, 7
  s_add_u32 s77, s77, s78
  s_waitcnt lgkmcnt(0)
  s_barrier
  ds_read_b128 v[80:83], v115
  ds_read_b128 v[84:87], v115 offset:16
  ds_read_b128 v[88:91], v115 offset:17408
  ds_read_b128 v[92:95], v115 offset:17424
  ds_read_b128 v[96:99], v115 offset:34816
  ds_read_b128 v[100:103], v115 offset:34832
  ds_read_b128 v[104:107], v115 offset:52224
  ds_read_b128 v[108:111], v115 offset:52240
  s_waitcnt lgkmcnt(5)
  v_pk_add_f32 v[80:81], v[80:81], v[88:89]
  s_waitcnt lgkmcnt(1)
  v_pk_add_f32 v[96:97], v[96:97], v[104:105]
  v_pk_add_f32 v[82:83], v[82:83], v[90:91]
  v_pk_add_f32 v[98:99], v[98:99], v[106:107]
  v_pk_add_f32 v[84:85], v[84:85], v[92:93]
  s_waitcnt lgkmcnt(0)
  v_pk_add_f32 v[100:101], v[100:101], v[108:109]
  v_pk_add_f32 v[86:87], v[86:87], v[94:95]
  v_pk_add_f32 v[102:103], v[102:103], v[110:111]
  v_pk_add_f32 v[80:81], v[80:81], v[96:97]
  v_pk_add_f32 v[82:83], v[82:83], v[98:99]
  v_pk_add_f32 v[84:85], v[84:85], v[100:101]
  v_pk_add_f32 v[86:87], v[86:87], v[102:103]
  v_cvt_pk_bf16_f32 v88, v80, v81
  v_cvt_pk_bf16_f32 v89, v82, v83
  v_cvt_pk_bf16_f32 v90, v84, v85
  v_cvt_pk_bf16_f32 v91, v86, v87
  buffer_store_dwordx4 v[88:91], v24, s[36:39], s77 offen
  s_endpgm
L_end:
  s_endpgm
.section .rodata,"a"
.p2align 6
.amdhsa_kernel gated_mix__linear_attn_block__glu_gated_swiglu__prompt_kernel
  .amdhsa_next_free_vgpr 256
  .amdhsa_next_free_sgpr 102
  .amdhsa_accum_offset 128
  .amdhsa_group_segment_fixed_size 0
  .amdhsa_kernarg_size 88
  .amdhsa_user_sgpr_count 2
  .amdhsa_user_sgpr_kernarg_segment_ptr 1
  .amdhsa_system_sgpr_workgroup_id_x 1
.end_amdhsa_kernel
```
